```python
import torch

def _softmax(x, axis=-1):
    return torch.softmax(x, dim=axis)

def _gelu(x):
    return torch.nn.functional.gelu(x, approximate='tanh')

def _silu(x):
    return torch.nn.functional.silu(x)

def _sigmoid(x):
    return torch.sigmoid(x)

def _layernorm(x, axis=-1, eps=1e-05):
    m = x.mean(dim=axis, keepdim=True)
    v = x.var(dim=axis, keepdim=True, unbiased=False)
    return (x - m) / torch.sqrt(v + eps)

def _scatter_add(tgt, idx, src, axis=0):
    return tgt.clone().index_add_(axis, idx, src)

def _segment_sum(src, seg, n):
    out = torch.zeros((n,) + src.shape[1:], dtype=src.dtype)
    return out.index_add_(0, seg, src)

def _pad(x, pw):
    flat = tuple((v for pair in reversed(pw) for v in pair))
    return torch.nn.functional.pad(x, flat)
kernel_name = 'adaLN_cond__sliding_block_cached__glu_gated_bilinear__decode'

def setup_inputs():

    _w = lambda a: (lambda t: t.to(torch.bfloat16) if t.is_floating_point() else t)(torch.as_tensor(a))

    def _A_setup():
        B, Sq, D = (1, 1, 512)
        Hq, Hkv, Sk, Dh = (32, 8, 32768, 128)
        assert Hq % Hkv == 0, (Hq, Hkv)
        return {'x': _w((lambda *s: torch.randn(*s, dtype=torch.bfloat16) * 0.05)(B, Sq, D)), 'k_cache': _w((lambda *s: torch.randn(*s, dtype=torch.bfloat16) * 0.8)(B, Hkv, Sk, Dh)), 'v_cache': _w((lambda *s: torch.randn(*s, dtype=torch.bfloat16) * 3.2)(B, Hkv, Sk, Dh)), 'wq': _w((lambda *s: torch.randn(*s, dtype=torch.bfloat16) * 0.8)(D, Hq * Dh) * D ** (-0.5)), 'wo': _w((lambda *s: torch.randn(*s, dtype=torch.bfloat16) * 3.2)(Hq * Dh, D) * (Hq * Dh) ** (-0.5))}
    _A_in = _A_setup()

    def _B_setup():
        B, S, D, F = (1, 1, 512, 1792)
        return {'x': _w((lambda *s: torch.randn(*s, dtype=torch.bfloat16) * 0.05)(B, S, D)), 'w_gate': _w((lambda *s: torch.randn(*s, dtype=torch.bfloat16) * 3.2)(D, F) * D ** (-0.5)), 'w_up': _w((lambda *s: torch.randn(*s, dtype=torch.bfloat16) * 3.2)(D, F) * D ** (-0.5)), 'w_down': _w((lambda *s: torch.randn(*s, dtype=torch.bfloat16) * 3.2)(F, D) * F ** (-0.5))}
    _B_in = _B_setup()
    return {'A_x': _A_in['x'], 'A_k_cache': _A_in['k_cache'], 'A_v_cache': _A_in['v_cache'], 'A_wq': _A_in['wq'], 'A_wo': _A_in['wo'], 'B_x': _B_in['x'], 'B_w_gate': _B_in['w_gate'], 'B_w_up': _B_in['w_up'], 'B_w_down': _B_in['w_down'], 'c': _w((lambda *s: torch.randn(*s, dtype=torch.bfloat16) * 0.4)(1, 512) * 8.0), 'w_mod': _w((lambda *s: torch.randn(*s, dtype=torch.bfloat16) * 0.4)(512, 6 * 512) * 512 ** (-0.5) * 8.0)}

def reference(A_x, A_k_cache, A_v_cache, A_wq, A_wo, B_x, B_w_gate, B_w_up, B_w_down, c, w_mod):

    def _A_ref(x, k_cache, v_cache, wq, wo):
        B, Sq, D = x.shape
        Hq, Dh = (32, 128)
        Hkv, Sk = (k_cache.shape[1], k_cache.shape[2])
        W = min(4096, max(256, Sk // 4))
        rep = Hq // Hkv
        q = (lambda x, *d: x.permute(*d))((x @ wq).reshape(B, Sq, Hq, Dh), 0, 2, 1, 3)
        k = (lambda x, n, axis: torch.repeat_interleave(x, n, dim=axis))(k_cache[:, :, Sk - W:, :], rep, axis=1)
        v = (lambda x, n, axis: torch.repeat_interleave(x, n, dim=axis))(v_cache[:, :, Sk - W:, :], rep, axis=1)
        scores = torch.einsum('bhqd,bhkd->bhqk', q, k) * Dh ** (-0.5)
        p = _softmax(scores, axis=-1)
        o = torch.einsum('bhqk,bhkd->bhqd', p, v)
        return (lambda x, *d: x.permute(*d))(o, 0, 2, 1, 3).reshape(B, Sq, Hq * Dh) @ wo

    def _B_ref(x, w_gate, w_up, w_down):
        g = torch.einsum('bsd,df->bsf', x, w_gate)
        u = torch.einsum('bsd,df->bsf', x, w_up)
        h = g * u
        return torch.einsum('bsf,fd->bsd', h, w_down)
    x = A_x
    mod = (_silu(c) @ w_mod).reshape(c.shape[0], 6, 1, -1)
    sa, ca, ga, sb, cb, gb = (mod[:, 0].clone(), mod[:, 1].clone(), mod[:, 2].clone(), mod[:, 3].clone(), mod[:, 4].clone(), mod[:, 5].clone())
    h = _layernorm(x, axis=-1) * (1 + ca) + sa
    x = x + ga * _A_ref(h, A_k_cache, A_v_cache, A_wq, A_wo)
    h = _layernorm(x, axis=-1) * (1 + cb) + sb
    x = x + gb * _B_ref(h, B_w_gate, B_w_up, B_w_down)
    return x
```

```asm
; @launch grid=(256,1,1) block=(512,1,1) lds=78592
.amdgcn_target "amdgcn-amd-amdhsa--gfx950"
.text
.globl adaLN_cond__sliding_block_cached__glu_gated_bilinear__decode_kernel
.p2align 8
.type adaLN_cond__sliding_block_cached__glu_gated_bilinear__decode_kernel,@function
adaLN_cond__sliding_block_cached__glu_gated_bilinear__decode_kernel:
    v_lshrrev_b32 v10, 6, v0
    s_load_dwordx16 s[16:31], s[0:1], 0
    s_load_dwordx8 s[32:39], s[0:1], 64
    s_load_dwordx4 s[40:43], s[0:1], 96
    v_readfirstlane_b32 s5, v10
    s_cmp_ge_u32 s2, 256
    s_cbranch_scc1 L_end
    s_lshr_b32 s4, s2, 3
    s_cmp_lg_u32 s5, 1
    s_cbranch_scc1 L_pf_1
    s_getpc_b64 s[8:9]
L_pc:
    s_sub_u32 s8, s8, L_pc-adaLN_cond__sliding_block_cached__glu_gated_bilinear__decode_kernel
    s_subb_u32 s9, s9, 0
    s_lshl_b32 s7, s4, 9
    v_and_b32 v11, 31, v0
    v_lshl_add_u32 v11, v11, 4, s7
    v_min_u32 v11, L_code_end-adaLN_cond__sliding_block_cached__glu_gated_bilinear__decode_kernel-16, v11
    global_load_dwordx4 v[252:255], v11, s[8:9]
L_pf_1:
    v_and_b32 v0, 63, v0
    s_and_b32 s3, s2, 7
    s_sub_u32 s6, s4, 16
    v_and_b32 v1, 15, v0
    v_lshrrev_b32 v2, 4, v0
    s_cmp_lt_u32 s4, 16
    s_cbranch_scc1 L_rest
    s_cmp_lg_u32 s5, 0
    s_cbranch_scc1 L_rest
    v_and_b32 v11, 7, v1
    v_lshlrev_b32 v11, 2, v11
    s_lshl_b32 s7, s6, 5
    v_add3_u32 v11, v11, v2, s7
    v_mul_u32_u24 v12, 6144, v2
    s_mul_i32 s7, s6, 196608
    s_lshl_b32 s8, s3, 8
    v_lshl_add_u32 v12, v1, 4, v12
    s_add_u32 s7, s7, s8
    v_lshlrev_b32 v11, 1, v11
    v_add_u32 v12, s7, v12
    s_movk_i32 s8, 24576
    s_waitcnt lgkmcnt(0)
    global_load_ushort v20, v11, s[34:35]
    global_load_dwordx4 v[64:67], v12, s[36:37] nt
    v_add_u32 v12, s8, v12
    global_load_dwordx4 v[68:71], v12, s[36:37] nt
    v_add_u32 v12, s8, v12
    global_load_dwordx4 v[72:75], v12, s[36:37] nt
    v_add_u32 v12, s8, v12
    global_load_dwordx4 v[76:79], v12, s[36:37] nt
    v_add_u32 v12, s8, v12
    global_load_dwordx4 v[80:83], v12, s[36:37] nt
    v_add_u32 v12, s8, v12
    global_load_dwordx4 v[84:87], v12, s[36:37] nt
    v_add_u32 v12, s8, v12
    global_load_dwordx4 v[88:91], v12, s[36:37] nt
    v_add_u32 v12, s8, v12
    global_load_dwordx4 v[92:95], v12, s[36:37] nt
L_rest:
    s_getreg_b32 s15, hwreg(HW_REG_XCC_ID)
    s_and_b32 s15, s15, 15
    s_lshl_b32 s15, s15, 8
    s_mov_b32 s65, 0xffff0000
    s_mov_b32 s66, 0x3fb8aa3b
    s_mov_b32 s100, 0x11111111
    s_mov_b32 s101, 0x11111111
    s_waitcnt lgkmcnt(0)
    s_mov_b32 s44, s42
    s_mov_b32 s45, s43
    s_mov_b32 s46, 0x400000
    s_mov_b32 s47, 0x20000
    s_load_dword s67, s[42:43], 0
    s_cmp_lt_u32 s4, 16
    s_cbranch_scc1 L_X
L_Y:
    s_mov_b32 s48, s36
    s_mov_b32 s49, s37
    s_mov_b32 s50, 0x300000
    s_mov_b32 s51, 0x20000
    s_mov_b32 s76, s34
    s_mov_b32 s77, s35
    s_mov_b32 s78, 0x400
    s_mov_b32 s79, 0x20000
    v_lshlrev_b32 v149, 4, v1
    s_cmp_lg_u32 s5, 0
    s_cbranch_scc1 L_noM_2
    s_barrier
    v_and_b32 v10, 1, v1
    v_lshlrev_b32 v10, 4, v10
    v_mov_b32 v11, 0xffff
    v_lshlrev_b32 v10, v10, v11
    v_lshrrev_b32 v11, 1, v1
    v_cmp_eq_u32 vcc, 0, v11
    s_lshl_b32 s7, s3, 4
    v_lshlrev_b32 v150, 1, v1
    v_cndmask_b32 v4, 0, v10, vcc
    v_cmp_eq_u32 vcc, 1, v11
    s_add_u32 s7, s7, s6
    v_add_u32 v150, v150, v2
    v_cndmask_b32 v5, 0, v10, vcc
    v_cmp_eq_u32 vcc, 2, v11
    s_lshl_b32 s7, s7, 9
    v_lshlrev_b32 v150, 4, v150
    v_cndmask_b32 v6, 0, v10, vcc
    v_cmp_eq_u32 vcc, 3, v11
    s_add_u32 s7, s7, 0x100000
    v_mov_b32 v3, 0xffffff00
    v_cndmask_b32 v7, 0, v10, vcc
    v_add_u32 v151, s7, v150
    s_waitcnt lgkmcnt(0)
    s_add_u32 s69, s67, 1
    s_mul_i32 s60, s69, 0x9E3779B1
    s_xor_b32 s60, s60, 0x5BD1E995
    s_and_b32 s61, s60, 0xff
    s_bfe_u32 s62, s60, 0x80008
    s_bfe_u32 s63, s60, 0x80010
    s_lshr_b32 s64, s60, 24
    s_waitcnt vmcnt(8)
    v_lshlrev_b32 v20, 16, v20
    v_mul_f32 v22, 0xbfb8aa3b, v20
    v_min_f32 v22, 0x42fc0000, v22
    v_exp_f32 v22, v22
    s_nop 0
    v_add_f32 v22, 1.0, v22
    v_rcp_f32 v30, v22
    s_nop 0
    v_mul_f32 v23, v20, v30
    v_fma_f32 v31, -v23, v22, v20
    v_fma_f32 v23, v31, v30, v23
    v_cvt_pk_bf16_f32 v20, v23, v23
    s_nop 1
    v_mov_b32_dpp v163, v20 row_newbcast:0 row_mask:0xf bank_mask:0xf
    v_mov_b32_dpp v167, v20 row_newbcast:1 row_mask:0xf bank_mask:0xf
    v_mov_b32_dpp v171, v20 row_newbcast:2 row_mask:0xf bank_mask:0xf
    v_mov_b32_dpp v175, v20 row_newbcast:3 row_mask:0xf bank_mask:0xf
    v_mov_b32_dpp v179, v20 row_newbcast:4 row_mask:0xf bank_mask:0xf
    v_mov_b32_dpp v183, v20 row_newbcast:5 row_mask:0xf bank_mask:0xf
    v_mov_b32_dpp v187, v20 row_newbcast:6 row_mask:0xf bank_mask:0xf
    v_mov_b32_dpp v191, v20 row_newbcast:7 row_mask:0xf bank_mask:0xf
    v_and_b32 v160, v163, v4
    v_and_b32 v161, v163, v5
    v_and_b32 v162, v163, v6
    v_and_b32 v164, v167, v4
    v_and_b32 v165, v167, v5
    v_and_b32 v166, v167, v6
    v_and_b32 v168, v171, v4
    v_and_b32 v169, v171, v5
    v_and_b32 v170, v171, v6
    v_and_b32 v172, v175, v4
    v_and_b32 v173, v175, v5
    v_and_b32 v174, v175, v6
    v_and_b32 v176, v179, v4
    v_and_b32 v177, v179, v5
    v_and_b32 v178, v179, v6
    v_and_b32 v180, v183, v4
    v_and_b32 v181, v183, v5
    v_and_b32 v182, v183, v6
    v_and_b32 v184, v187, v4
    v_and_b32 v185, v187, v5
    v_and_b32 v186, v187, v6
    v_and_b32 v188, v191, v4
    v_and_b32 v189, v191, v5
    v_and_b32 v190, v191, v6
    v_and_b32 v163, v163, v7
    v_and_b32 v167, v167, v7
    v_and_b32 v171, v171, v7
    v_and_b32 v175, v175, v7
    v_and_b32 v179, v179, v7
    v_and_b32 v183, v183, v7
    v_and_b32 v187, v187, v7
    v_and_b32 v191, v191, v7
    s_waitcnt vmcnt(0)
    v_mfma_f32_16x16x32_bf16 v[60:63], v[160:163], v[64:67], 0
    v_mfma_f32_16x16x32_bf16 v[60:63], v[164:167], v[68:71], v[60:63]
    v_mfma_f32_16x16x32_bf16 v[60:63], v[168:171], v[72:75], v[60:63]
    v_mfma_f32_16x16x32_bf16 v[60:63], v[172:175], v[76:79], v[60:63]
    v_mfma_f32_16x16x32_bf16 v[60:63], v[176:179], v[80:83], v[60:63]
    v_mfma_f32_16x16x32_bf16 v[60:63], v[180:183], v[84:87], v[60:63]
    v_mfma_f32_16x16x32_bf16 v[60:63], v[184:187], v[88:91], v[60:63]
    v_mfma_f32_16x16x32_bf16 v[60:63], v[188:191], v[92:95], v[60:63]
    s_nop 7
    v_add_u32 v16, 0x80, v60
    v_add_u32 v17, 0x80, v61
    v_add_u32 v18, 0x80, v62
    v_add_u32 v19, 0x80, v63
    v_and_or_b32 v16, v16, v3, s61
    v_and_or_b32 v17, v17, v3, s62
    v_and_or_b32 v18, v18, v3, s63
    v_and_or_b32 v19, v19, v3, s64
    s_mov_b32 exec_hi, 0
    buffer_store_dwordx4 v[16:19], v151, s[44:47], 0 offen sc1
    s_mov_b32 s72, 0x10000
    buffer_store_dwordx4 v[16:19], v151, s[44:47], s72 offen sc1
    s_mov_b32 s72, 0x20000
    buffer_store_dwordx4 v[16:19], v151, s[44:47], s72 offen sc1
    s_mov_b32 s72, 0x30000
    buffer_store_dwordx4 v[16:19], v151, s[44:47], s72 offen sc1
    s_mov_b32 s72, 0x40000
    buffer_store_dwordx4 v[16:19], v151, s[44:47], s72 offen sc1
    s_mov_b32 s72, 0x50000
    buffer_store_dwordx4 v[16:19], v151, s[44:47], s72 offen sc1
    s_mov_b32 s72, 0x60000
    buffer_store_dwordx4 v[16:19], v151, s[44:47], s72 offen sc1
    s_mov_b32 s72, 0x70000
    buffer_store_dwordx4 v[16:19], v151, s[44:47], s72 offen sc1
    s_mov_b64 exec, -1
    s_barrier
    s_branch L_mdone_3
L_noM_2:
    s_barrier
L_mdone_3:
    v_and_b32 v10, 1, v1
    v_lshlrev_b32 v10, 4, v10
    v_mov_b32 v11, 0xffff
    v_lshlrev_b32 v10, v10, v11
    v_lshrrev_b32 v11, 1, v1
    v_cmp_eq_u32 vcc, 0, v11
    s_mov_b32 s56, s16
    s_mov_b32 s57, s17
    v_cndmask_b32 v4, 0, v10, vcc
    v_cmp_eq_u32 vcc, 1, v11
    s_mov_b32 s58, 0x400
    s_mov_b32 s59, 0x20000
    v_cndmask_b32 v5, 0, v10, vcc
    v_cmp_eq_u32 vcc, 2, v11
    v_lshlrev_b32 v12, 4, v0
    buffer_load_dwordx4 v[48:51], v12, s[56:59], 0 offen
    s_lshr_b32 s8, s6, 2
    v_and_b32 v12, 3, v1
    v_cndmask_b32 v6, 0, v10, vcc
    s_lshl_b32 s10, s8, 7
    s_lshl_b32 s11, s5, 4
    v_lshlrev_b32 v12, 2, v12
    v_cmp_eq_u32 vcc, 3, v11
    s_add_u32 s10, s10, s11
    v_add_u32 v12, v12, v2
    v_add_u32 v12, s10, v12
    s_lshl_b32 s11, s10, 13
    s_lshl_b32 s12, s3, 10
    v_lshlrev_b32 v12, 1, v12
    s_add_u32 s11, s11, s12
    v_cndmask_b32 v7, 0, v10, vcc
    v_and_b32 v11, 1, v11
    buffer_load_ushort v21, v12, s[56:59], 0 offen
    v_cmp_eq_u32 vcc, 0, v11
    s_lshl_b32 s7, s8, 13
    s_lshl_b32 s12, s5, 6
    v_lshrrev_b32 v11, 2, v0
    v_and_b32 v12, 3, v0
    s_add_u32 s7, s7, s12
    v_lshlrev_b32 v11, 9, v11
    v_lshlrev_b32 v12, 4, v12
    s_add_u32 s7, s7, 0x100000
    s_lshl_b32 s12, s3, 16
    v_add_u32 v153, v11, v12
    s_add_u32 s7, s7, s12
    v_add_u32 v152, s7, v153
    v_and_b32 v154, 31, v0
    s_lshl_b32 s7, s3, 7
    v_lshlrev_b32 v154, 10, v154
    s_add_u32 s7, s7, 0x8000
    v_lshlrev_b32 v16, 1, v1
    v_add_u32 v154, s7, v154
    v_add_u32 v16, v16, v2
    v_lshlrev_b32 v16, 4, v16
    s_mul_i32 s7, s5, 576
    v_add_u32 v155, s7, v16
    s_and_b32 s9, s6, 3
    s_lshl_b32 s7, s3, 2
    v_lshlrev_b32 v13, 13, v2
    s_lshl_b32 s13, s9, 8
    s_add_u32 s7, s7, s9
    v_add_u32 v13, v13, v149
    s_add_u32 s11, s11, s13
    s_lshr_b32 s9, s6, 2
    v_add_u32 v13, s11, v13
    s_and_b32 s9, s9, 1
    s_lshl_b32 s10, s3, 9
    s_lshl_b32 s11, s9, 8
    s_lshl_b32 s7, s7, 2
    s_add_u32 s10, s10, s11
    s_add_u32 s7, s7, s8
    s_lshl_b32 s11, s5, 5
    s_and_b32 s8, s6, 3
    s_add_u32 s10, s10, s11
    v_lshlrev_b32 v12, 10, v2
    s_lshl_b32 s10, s10, 10
    s_lshl_b32 s11, s8, 8
    v_add_u32 v12, v12, v149
    s_add_u32 s10, s10, s11
    s_lshl_b32 s12, s5, 4
    v_lshrrev_b32 v18, 2, v0
    v_add_u32 v144, s10, v12
    v_add_u32 v18, s12, v18
    s_lshl_b32 s10, s9, 1
    s_lshr_b32 s11, s5, 2
    v_lshlrev_b32 v18, 4, v18
    s_lshl_b32 s7, s7, 9
    s_add_u32 s10, s10, s11
    v_mov_b32 v158, v18
    s_add_u32 s7, s7, 0x10000
    s_lshl_b32 s11, s3, 2
    v_add_u32 v157, s7, v158
    s_add_u32 s10, s10, s11
    v_cndmask_b32 v8, 0, v10, vcc
    v_cndmask_b32 v9, v10, 0, vcc
    s_lshl_b32 s11, s10, 2
    s_and_b32 s7, s5, 3
    v_and_b32 v16, 3, v0
    s_add_u32 s11, s11, s7
    v_cmp_eq_u32 vcc, 3, v16
    s_lshl_b32 s11, s11, 12
    s_add_u32 s11, s11, 0x180000
    v_lshlrev_b32 v15, 4, v0
    v_add_u32 v145, s11, v15
    v_cndmask_b32 v16, v16, 0, vcc
    s_bfe_u32 s7, s5, 0x10001
    v_lshrrev_b32 v15, 3, v0
    v_lshlrev_b32 v16, 3, v16
    s_lshl_b32 s11, s10, 10
    s_lshl_b32 s7, s7, 9
    s_mov_b32 s52, s22
    s_mov_b32 s53, s23
    s_mov_b32 s54, 0x400000
    s_mov_b32 s55, 0x20000
    v_add_u32 v15, v15, v16
    s_add_u32 s11, s11, s7
    buffer_load_dwordx4 v[32:35], v13, s[52:55], 0 offen nt
    s_mov_b32 s72, 0x8000
    v_lshlrev_b32 v15, 4, v15
    s_add_u32 s11, s11, 0x20000
    s_lshl_b32 s7, s3, 1
    buffer_load_dwordx4 v[36:39], v13, s[52:55], s72 offen nt
    v_and_b32 v17, 3, v0
    v_add_u32 v146, s11, v15
    s_add_u32 s7, s7, s9
    s_mov_b32 s72, 0x10000
    v_mul_u32_u24 v17, 576, v17
    s_lshl_b32 s7, s7, 11
    s_lshl_b32 s11, s8, 9
    buffer_load_dwordx4 v[40:43], v13, s[52:55], s72 offen nt
    v_add_u32 v156, v17, v18
    s_add_u32 s7, s7, s11
    s_mov_b32 s72, 0x18000
    v_mov_b32 v148, 0
    v_mov_b32 v17, 0xff800000
    s_add_u32 s7, s7, 0xa0000
    buffer_load_dwordx4 v[44:47], v13, s[52:55], s72 offen nt
    v_mov_b32 v3, 0xffffff00
    v_mov_b32 v159, 21120
    v_cndmask_b32 v148, v148, v17, vcc
    v_add_u32 v147, s7, v158
    s_waitcnt lgkmcnt(0)
    s_add_u32 s69, s67, 1
    s_mul_i32 s60, s69, 0x9E3779B1
    s_xor_b32 s60, s60, 0x5BD1E995
    s_lshl_b32 s11, s2, 7
    s_and_b32 s61, s60, 0xff
    s_bfe_u32 s62, s60, 0x80008
    s_bfe_u32 s63, s60, 0x80010
    s_lshr_b32 s64, s60, 24
    s_add_u32 s11, s11, 0x8000
    s_cmp_lg_u32 s5, 1
    s_cbranch_scc1 L_nofl_4
    s_or_b32 s7, s15, s61
    v_mov_b32 v16, s7
    v_mov_b32 v17, s62
    v_mov_b32 v18, s63
    v_mov_b32 v19, s64
    v_mov_b32 v20, s11
    s_mov_b64 exec, 1
    buffer_store_dwordx4 v[16:19], v20, s[44:47], 0 offen sc1
    s_mov_b64 exec, -1
L_nofl_4:
    s_mul_i32 s7, s4, 96
    s_lshl_b32 s8, s5, 4
    s_add_u32 s7, s7, s8
    s_add_u32 s7, s7, 29664
    s_lshl_b32 s7, s7, 8
    s_lshl_b32 s8, s3, 23
    v_add_u32 v190, 0, v2
    v_add_u32 v191, 4, v2
    v_add_u32 v192, 8, v2
    v_add_u32 v193, 12, v2
    s_add_u32 s12, s7, s8
    v_lshlrev_b32 v10, 8, v2
    v_xor_b32 v190, v190, v1
    v_xor_b32 v191, v191, v1
    v_xor_b32 v192, v192, v1
    v_xor_b32 v193, v193, v1
    s_lshl_b32 s13, s5, 12
    v_lshlrev_b32 v11, 10, v2
    v_lshlrev_b32 v12, 4, v1
    v_add_u32 v10, s12, v10
    v_lshlrev_b32 v190, 4, v190
    v_lshlrev_b32 v191, 4, v191
    v_lshlrev_b32 v192, 4, v192
    v_lshlrev_b32 v193, 4, v193
    s_add_u32 s13, s13, 21248
    v_add_u32 v11, v11, v12
    v_add_u32 v190, v190, v10
    v_add_u32 v191, v191, v10
    v_add_u32 v192, v192, v10
    v_add_u32 v193, v193, v10
    v_add_u32 v198, s12, v11
    s_cmp_eq_u32 s5, 0
    s_cbranch_scc1 L_b0_5
    s_barrier
L_b0_5:
    s_mov_b32 s52, s18
    s_mov_b32 s53, s19
    s_mov_b32 s54, 0x4000000
    s_mov_b32 s55, 0x20000
    s_cmp_lt_u32 s6, 8
    s_cbranch_scc1 L_nold_6
    s_cmp_lt_u32 s5, 2
    s_cbranch_scc1 L_nold_6
    s_mov_b32 m0, s13
    s_nop 0
    buffer_load_dwordx4 v190, s[52:55], 0 offen nt lds
    buffer_load_dwordx4 v191, s[52:55], 0 offen offset:1024 nt lds
    buffer_load_dwordx4 v192, s[52:55], 0 offen offset:2048 nt lds
    buffer_load_dwordx4 v193, s[52:55], 0 offen offset:3072 nt lds
L_nold_6:
    s_lshr_b32 s9, s6, 2
    s_and_b32 s9, s9, 1
    s_lshl_b32 s10, s3, 1
    s_and_b32 s8, s6, 3
    s_add_u32 s9, s9, s10
    s_lshl_b32 s10, s8, 7
    s_lshl_b32 s11, s5, 4
    s_add_u32 s10, s10, s11
    v_and_b32 v12, 3, v1
    v_lshlrev_b32 v12, 2, v12
    s_mul_i32 s11, s10, 6144
    s_lshl_b32 s7, s9, 8
    v_add_u32 v12, v12, v2
    s_add_u32 s11, s11, s7
    v_add_u32 v12, s10, v12
    s_lshl_b32 s7, s9, 2
    v_lshlrev_b32 v244, 1, v12
    s_add_u32 s7, s7, s8
    v_mul_u32_u24 v12, 6144, v2
    s_lshl_b32 s7, s7, 9
    v_add_u32 v12, v12, v149
    s_add_u32 s11, s11, 2048
    s_add_u32 s7, s7, 0x90000
    s_lshr_b32 s8, s5, 1
    s_lshl_b32 s10, s3, 2
    v_add_u32 v245, s11, v12
    v_add_u32 v246, s7, v158
    s_and_b32 s9, s5, 1
    s_add_u32 s10, s10, s8
    s_lshl_b32 s11, s10, 11
    s_lshl_b32 s7, s9, 8
    s_add_u32 s11, s11, s7
    v_lshlrev_b32 v12, 9, v2
    v_lshlrev_b32 v13, 4, v1
    s_add_u32 s11, s11, 0x10000
    v_add_u32 v12, v12, v13
    v_add_u32 v186, s11, v12
    v_lshrrev_b32 v14, 2, v0
    s_lshl_b32 s11, s5, 4
    v_and_b32 v15, 3, v0
    v_add_u32 v16, s11, v14
    v_lshlrev_b32 v16, 4, v16
    v_mul_u32_u24 v17, 2112, v15
    v_add_u32 v242, v16, v17
    s_lshl_b32 s11, s8, 5
    s_add_u32 s11, s11, 17920
    v_lshlrev_b32 v17, 2, v15
    v_mov_b32 v207, s11
    v_add_u32 v243, s11, v17
    s_lshl_b32 s11, s10, 2
    s_lshl_b32 s7, s9, 1
    s_add_u32 s11, s11, s7
    s_sub_u32 s99, s4, 8
    s_lshl_b32 s11, s11, 5
    s_add_u32 s11, s11, s99
    s_lshl_b32 s7, s11, 7
    v_lshrrev_b32 v16, 3, v14
    v_and_b32 v17, 7, v14
    s_lshl_b32 s11, s10, 1
    v_lshlrev_b32 v16, 12, v16
    v_lshlrev_b32 v17, 4, v17
    s_add_u32 s11, s11, s9
    s_add_u32 s7, s7, 0x180000
    v_add_u32 v16, v16, v17
    s_lshl_b32 s11, s11, 5
    v_add_u32 v248, s7, v16
    s_add_u32 s11, s11, s99
    s_lshl_b32 s7, s11, 4
    s_lshl_b32 s10, s8, 8
    s_lshl_b32 s11, s9, 7
    s_add_u32 s10, s10, s11
    v_lshlrev_b32 v12, 3, v1
    v_lshlrev_b32 v14, 1, v2
    s_add_u32 s10, s10, 16896
    v_add_u32 v12, v12, v14
    v_add_u32 v188, s10, v12
    v_lshrrev_b32 v12, 2, v1
    v_lshlrev_b32 v14, 8, v12
    v_lshlrev_b32 v15, 4, v2
    s_add_u32 s7, s7, 0x20000
    v_add_u32 v189, v14, v15
    v_add_u32 v194, 0, v2
    v_add_u32 v195, 4, v2
    v_add_u32 v196, 8, v2
    v_add_u32 v197, 12, v2
    v_mov_b32 v249, s7
    v_lshlrev_b32 v14, 8, v1
    v_xor_b32 v194, v194, v1
    v_xor_b32 v195, v195, v1
    v_xor_b32 v196, v196, v1
    v_xor_b32 v197, v197, v1
    s_lshl_b32 s7, s3, 7
    v_add_u32 v14, s13, v14
    v_lshlrev_b32 v194, 4, v194
    v_lshlrev_b32 v195, 4, v195
    v_lshlrev_b32 v196, 4, v196
    v_lshlrev_b32 v197, 4, v197
    s_add_u32 s7, s7, 0x8000
    v_add_u32 v194, v194, v14
    v_add_u32 v195, v195, v14
    v_add_u32 v196, v196, v14
    v_add_u32 v197, v197, v14
    s_lshl_b32 s10, s5, 2
    v_lshlrev_b32 v14, 5, v12
    s_add_u32 s10, s10, 17920
    v_add_u32 v199, s10, v14
    v_and_b32 v187, 31, v0
    v_lshlrev_b32 v14, 9, v2
    v_lshlrev_b32 v15, 5, v1
    v_lshlrev_b32 v187, 10, v187
    v_add_u32 v14, v14, v15
    s_mul_i32 s10, s5, 2112
    v_mov_b32 v200, 0x3db504f3
    v_mov_b32 v202, 0x3fb8aa3b
    v_mov_b32 v208, 0
    v_mov_b32 v209, 0
    v_mov_b32 v212, 0
    v_mov_b32 v213, 0
    v_mov_b32 v216, 0
    v_mov_b32 v217, 0
    v_mov_b32 v220, 0
    v_mov_b32 v221, 0
    v_mov_b32 v224, 0
    v_mov_b32 v225, 0
    v_mov_b32 v228, 0
    v_mov_b32 v229, 0
    v_mov_b32 v232, 0
    v_mov_b32 v233, 0
    v_mov_b32 v236, 0
    v_mov_b32 v237, 0
    v_mov_b32 v240, 0
    v_mov_b32 v241, 0
    v_add_u32 v187, s7, v187
    v_add_u32 v206, s10, v14
    v_mov_b32 v250, 21120
    s_waitcnt vmcnt(8)
    s_cmp_ge_u32 s6, 8
    s_cbranch_scc1 L_lx_7
    s_waitcnt vmcnt(4)
L_lx_7:
    s_cmp_ge_u32 s5, 2
    s_cbranch_scc1 L_lx_8
    s_waitcnt vmcnt(4)
L_lx_8:
    v_lshlrev_b32 v52, 16, v48
    v_and_b32 v53, s65, v48
    v_readfirstlane_b32 s98, v52
    v_lshlrev_b32 v54, 16, v49
    v_and_b32 v55, s65, v49
    v_subrev_f32 v52, s98, v52
    v_subrev_f32 v53, s98, v53
    v_subrev_f32 v54, s98, v54
    v_subrev_f32 v55, s98, v55
    v_lshlrev_b32 v56, 16, v50
    v_and_b32 v57, s65, v50
    v_lshlrev_b32 v58, 16, v51
    v_and_b32 v59, s65, v51
    v_add_f32 v24, v52, v53
    v_add_f32 v26, v54, v55
    v_mul_f32 v25, v52, v52
    v_mul_f32 v27, v53, v53
    v_subrev_f32 v56, s98, v56
    v_subrev_f32 v57, s98, v57
    v_subrev_f32 v58, s98, v58
    v_subrev_f32 v59, s98, v59
    v_add_f32 v24, v24, v26
    v_fmac_f32 v25, v54, v54
    v_fmac_f32 v27, v55, v55
    v_add_f32 v28, v56, v57
    v_add_f32 v26, v58, v59
    v_fmac_f32 v25, v56, v56
    v_fmac_f32 v27, v57, v57
    v_fmac_f32 v25, v58, v58
    v_fmac_f32 v27, v59, v59
    v_add_f32 v28, v28, v26
    v_add_f32 v24, v24, v28
    v_add_f32 v25, v25, v27
    v_lshlrev_b32 v21, 16, v21
    v_add_f32_dpp v24, v24, v24 row_ror:8 row_mask:0xf bank_mask:0xf
    v_add_f32_dpp v25, v25, v25 row_ror:8 row_mask:0xf bank_mask:0xf
    s_mov_b32 s73, 0x8000
    v_add_f32_dpp v24, v24, v24 row_ror:4 row_mask:0xf bank_mask:0xf
    v_add_f32_dpp v25, v25, v25 row_ror:4 row_mask:0xf bank_mask:0xf
    s_nop 0
    v_add_f32_dpp v24, v24, v24 row_ror:2 row_mask:0xf bank_mask:0xf
    v_add_f32_dpp v25, v25, v25 row_ror:2 row_mask:0xf bank_mask:0xf
    s_nop 0
    v_add_f32_dpp v24, v24, v24 row_ror:1 row_mask:0xf bank_mask:0xf
    v_add_f32_dpp v25, v25, v25 row_ror:1 row_mask:0xf bank_mask:0xf
    v_mov_b32 v26, v24
    v_mov_b32 v27, v25
    s_nop 0
    v_permlane16_swap_b32 v24, v26
    v_permlane16_swap_b32 v25, v27
    v_add_f32 v24, v24, v26
    v_add_f32 v25, v25, v27
    v_mov_b32 v26, v24
    v_mov_b32 v27, v25
    s_nop 0
    v_permlane32_swap_b32 v24, v26
    v_permlane32_swap_b32 v25, v27
    v_add_f32 v24, v24, v26
    v_add_f32 v25, v25, v27
    v_mul_f32 v24, 0x3b000000, v24
    v_mul_f32 v25, 0x3b000000, v25
    v_fma_f32 v25, -v24, v24, v25
    v_max_f32 v25, 0, v25
    v_cvt_pk_bf16_f32 v25, v25, v25
    v_and_b32 v25, s65, v25
    v_add_f32 v25, 0x3727c5ac, v25
    v_cvt_pk_bf16_f32 v25, v25, v25
    v_and_b32 v25, s65, v25
    v_add_f32 v24, s98, v24
    v_sqrt_f32 v25, v25
    v_cvt_pk_bf16_f32 v22, v24, v24
    v_and_b32 v22, s65, v22
    v_cvt_pk_bf16_f32 v23, v25, v25
    v_and_b32 v23, s65, v23
    v_sub_f32 v24, v21, v22
    v_cvt_pk_bf16_f32 v24, v24, v24
    v_rcp_f32 v25, v23
    v_and_b32 v24, s65, v24
    v_mul_f32 v21, v24, v25
    v_fma_f32 v26, -v21, v23, v24
    v_fma_f32 v21, v26, v25, v21
    v_cvt_pk_bf16_f32 v21, v21, v21
    v_and_b32 v21, s65, v21
    s_waitcnt vmcnt(0)
    s_cmp_eq_u32 s5, 7
    s_cbranch_scc1 L_p7_9
    s_mov_b32 s68, 0
L_e1_11:
    buffer_load_dwordx4 v[52:55], v152, s[44:47], 0 offen sc1
    buffer_load_dwordx4 v[56:59], v152, s[44:47], s73 offen sc1
    s_waitcnt vmcnt(0)
    v_xor_b32 v52, s61, v52
    v_xor_b32 v56, s61, v56
    v_or_b32 v24, v52, v56
    v_and_b32 v25, 0xff, v24
    v_cmp_ne_u32 vcc, 0, v25
    s_nop 0
    s_cbranch_vccnz L_e1_r_12
    v_xor_b32 v53, s62, v53
    v_xor_b32 v54, s63, v54
    v_xor_b32 v55, s64, v55
    v_xor_b32 v57, s62, v57
    v_xor_b32 v58, s63, v58
    v_or3_b32 v24, v53, v54, v55
    v_xor_b32 v59, s64, v59
    v_or3_b32 v24, v57, v58, v24
    v_or_b32 v24, v24, v59
    v_and_b32 v24, 0xff, v24
    v_cmp_ne_u32 vcc, 0, v24
    s_nop 0
    s_cbranch_vccz L_e1_ok_13
L_e1_r_12:
    s_add_u32 s68, s68, 1
    s_cmp_lt_u32 s68, 32768
    s_cbranch_scc1 L_e1_11
    s_branch L_end
L_e1_ok_13:
    s_branch L_pd_10
L_p7_9:
    s_mov_b32 s68, 0
L_e1x_14:
    buffer_load_dwordx4 v[52:55], v152, s[44:47], 0 offen sc1
    buffer_load_dwordx4 v[56:59], v152, s[44:47], s73 offen sc1
    buffer_load_dwordx4 v[64:67], v154, s[44:47], 0 offen sc1
    s_waitcnt vmcnt(0)
    v_xor_b32 v52, s61, v52
    v_xor_b32 v56, s61, v56
    v_xor_b32 v64, s61, v64
    v_or3_b32 v24, v52, v56, v64
    v_and_b32 v25, 0xff, v24
    v_cmp_ne_u32 vcc, 0, v25
    s_nop 0
    s_cbranch_vccnz L_e1x_r_15
    v_xor_b32 v53, s62, v53
    v_xor_b32 v54, s63, v54
    v_xor_b32 v55, s64, v55
    v_xor_b32 v57, s62, v57
    v_xor_b32 v58, s63, v58
    v_or3_b32 v24, v53, v54, v55
    v_xor_b32 v59, s64, v59
    v_or3_b32 v24, v57, v58, v24
    v_xor_b32 v65, s62, v65
    v_xor_b32 v66, s63, v66
    v_or_b32 v24, v24, v59
    v_xor_b32 v67, s64, v67
    v_or3_b32 v24, v65, v66, v24
    v_or_b32 v24, v24, v67
    v_and_b32 v24, 0xff, v24
    v_cmp_ne_u32 vcc, 0, v24
    s_nop 0
    s_cbranch_vccz L_e1x_ok_16
L_e1x_r_15:
    s_add_u32 s68, s68, 1
    s_cmp_lt_u32 s68, 32768
    s_cbranch_scc1 L_e1x_14
    s_branch L_end
L_e1x_ok_16:
    v_cmp_ne_u32 vcc, s15, v64
    v_mov_b32 v25, 21120
    s_cmp_eq_u64 vcc, 0
    s_cselect_b32 s7, 1, 0
    v_mov_b32 v24, s7
    ds_write_b32 v25, v24
L_pd_10:
    v_permlane32_swap_b32 v56, v58
    v_permlane32_swap_b32 v57, v59
    v_add_f32 v56, v56, v58
    v_add_f32 v57, v57, v59
    v_permlane32_swap_b32 v52, v54
    v_permlane32_swap_b32 v53, v55
    v_permlane16_swap_b32 v56, v57
    v_add_f32 v56, v56, v57
    v_add_f32 v52, v52, v54
    v_add_f32 v53, v53, v55
    v_add_f32_dpp v56, v56, v56 row_ror:8 row_mask:0xf bank_mask:0xf
    s_nop 0
    v_permlane16_swap_b32 v52, v53
    v_add_f32 v52, v52, v53
    v_add_f32_dpp v56, v56, v56 row_ror:4 row_mask:0xf bank_mask:0xf
    v_cvt_pk_bf16_f32 v56, v56, v56
    v_and_b32 v56, s65, v56
    v_add_f32_dpp v52, v52, v52 row_ror:8 row_mask:0xf bank_mask:0xf
    v_add_f32 v24, 1.0, v56
    v_cvt_pk_bf16_f32 v24, v24, v24
    v_and_b32 v24, s65, v24
    v_add_f32_dpp v52, v52, v52 row_ror:4 row_mask:0xf bank_mask:0xf
    v_mul_f32 v24, v21, v24
    v_cvt_pk_bf16_f32 v52, v52, v52
    v_cvt_pk_bf16_f32 v24, v24, v24
    v_and_b32 v52, s65, v52
    v_and_b32 v24, s65, v24
    v_add_f32 v24, v24, v52
    v_cvt_pk_bf16_f32 v20, v24, v24
    s_nop 1
    v_mov_b32_dpp v163, v20 row_newbcast:0 row_mask:0xf bank_mask:0xf
    v_and_b32 v160, v163, v4
    v_and_b32 v161, v163, v5
    v_and_b32 v162, v163, v6
    v_and_b32 v163, v163, v7
    v_mov_b32_dpp v167, v20 row_newbcast:1 row_mask:0xf bank_mask:0xf
    v_and_b32 v164, v167, v4
    v_mfma_f32_16x16x32_bf16 v[60:63], v[160:163], v[32:35], 0
    v_and_b32 v165, v167, v5
    v_and_b32 v166, v167, v6
    v_and_b32 v167, v167, v7
    v_mov_b32_dpp v171, v20 row_newbcast:2 row_mask:0xf bank_mask:0xf
    v_and_b32 v168, v171, v4
    v_mfma_f32_16x16x32_bf16 v[60:63], v[164:167], v[36:39], v[60:63]
    v_and_b32 v169, v171, v5
    v_and_b32 v170, v171, v6
    v_and_b32 v171, v171, v7
    v_mov_b32_dpp v175, v20 row_newbcast:3 row_mask:0xf bank_mask:0xf
    v_and_b32 v172, v175, v4
    v_mfma_f32_16x16x32_bf16 v[60:63], v[168:171], v[40:43], v[60:63]
    v_and_b32 v173, v175, v5
    v_and_b32 v174, v175, v6
    v_and_b32 v175, v175, v7
    s_nop 1
    v_mfma_f32_16x16x32_bf16 v[60:63], v[172:175], v[44:47], v[60:63]
    s_mov_b32 exec_hi, 0
    s_nop 6
    ds_write_b128 v155, v[60:63]
    s_mov_b64 exec, -1
    s_waitcnt lgkmcnt(0)
    s_barrier
    s_cmp_ge_u32 s5, 2
    s_cbranch_scc1 L_qpub_17
    ds_read_b32 v25, v159
    ds_read_b128 v[64:67], v156 offset:0
    ds_read_b128 v[68:71], v156 offset:2304
    s_waitcnt lgkmcnt(0)
    v_add_f32 v64, v64, v68
    v_add_f32 v65, v65, v69
    v_add_f32 v66, v66, v70
    v_add_f32 v67, v67, v71
    v_add_f32_dpp v64, v64, v64 quad_perm:[1,0,3,2] row_mask:0xf bank_mask:0xf
    v_add_f32_dpp v65, v65, v65 quad_perm:[1,0,3,2] row_mask:0xf bank_mask:0xf
    v_add_f32_dpp v66, v66, v66 quad_perm:[1,0,3,2] row_mask:0xf bank_mask:0xf
    v_add_f32_dpp v67, v67, v67 quad_perm:[1,0,3,2] row_mask:0xf bank_mask:0xf
    v_add_f32_dpp v64, v64, v64 quad_perm:[2,3,0,1] row_mask:0xf bank_mask:0xf
    v_add_f32_dpp v65, v65, v65 quad_perm:[2,3,0,1] row_mask:0xf bank_mask:0xf
    v_add_f32_dpp v66, v66, v66 quad_perm:[2,3,0,1] row_mask:0xf bank_mask:0xf
    v_add_f32_dpp v67, v67, v67 quad_perm:[2,3,0,1] row_mask:0xf bank_mask:0xf
    v_add_u32 v16, 0x80, v64
    v_add_u32 v17, 0x80, v65
    v_add_u32 v18, 0x80, v66
    v_add_u32 v19, 0x80, v67
    v_readfirstlane_b32 s14, v25
    v_and_or_b32 v16, v16, v3, s61
    v_and_or_b32 v17, v17, v3, s62
    v_and_or_b32 v18, v18, v3, s63
    v_and_or_b32 v19, v19, v3, s64
    s_mov_b64 exec, s[100:101]
    s_cmp_eq_u32 s14, 0
    s_cbranch_scc1 L_slow_18
    buffer_store_dwordx4 v[16:19], v157, s[44:47], 0 offen
    s_branch L_std_19
L_slow_18:
    buffer_store_dwordx4 v[16:19], v157, s[44:47], 0 offen sc1
L_std_19:
    s_mov_b64 exec, -1
L_qpub_17:
    s_cmp_lt_u32 s6, 8
    s_cbranch_scc1 L_O
    s_barrier
    s_mov_b32 s52, s18
    s_mov_b32 s53, s19
    s_mov_b32 s54, 0x4000000
    s_mov_b32 s55, 0x20000
    s_mov_b32 s56, s20
    s_mov_b32 s57, s21
    s_mov_b32 s58, 0x4000000
    s_mov_b32 s59, 0x20000
    s_cmp_lt_u32 s6, 8
    s_cbranch_scc1 L_nold_20
    s_cmp_lt_u32 s5, 2
    s_cbranch_scc1 L_nold_20
    buffer_load_dwordx4 v[128:131], v198, s[56:59], 0 offen nt
    buffer_load_dwordx4 v[132:135], v198, s[56:59], 0 offen offset:256 nt
    buffer_load_dwordx4 v[136:139], v198, s[56:59], 0 offen offset:512 nt
    buffer_load_dwordx4 v[140:143], v198, s[56:59], 0 offen offset:768 nt
L_nold_20:
    s_waitcnt vmcnt(4)
    ds_read_b128 v[32:35], v194
    ds_read_b128 v[36:39], v195
    ds_read_b128 v[40:43], v196
    ds_read_b128 v[44:47], v197
    s_mov_b32 s68, 0
L_e2y_23:
    buffer_load_dwordx4 v[96:99], v186, s[44:47], 0 offen sc1
    s_waitcnt vmcnt(0)
    v_xor_b32 v96, s61, v96
    v_xor_b32 v97, s62, v97
    v_xor_b32 v98, s63, v98
    v_xor_b32 v99, s64, v99
    v_or3_b32 v24, v96, v97, v98
    v_or_b32 v24, v24, v99
    v_and_b32 v24, 0xff, v24
    v_cmp_ne_u32 s[70:71], 0, v24
    s_nop 0
    s_cmp_eq_u64 s[70:71], 0
    s_cbranch_scc1 L_e2y_ok_25
L_e2y_r_24:
    s_add_u32 s68, s68, 1
    s_cmp_lt_u32 s68, 32768
    s_cbranch_scc1 L_e2y_23
    s_branch L_end
L_e2y_ok_25:
    v_permlane32_swap_b32 v96, v98
    v_permlane32_swap_b32 v97, v99
    v_add_f32 v96, v96, v98
    v_add_f32 v97, v97, v99
    s_nop 1
    v_permlane16_swap_b32 v96, v97
    v_add_f32 v96, v96, v97
    v_cvt_pk_bf16_f32 v96, v96, v96
    ds_write_b16 v188, v96
    s_waitcnt lgkmcnt(0)
    s_barrier
    s_mov_b32 s48, s36
    s_mov_b32 s49, s37
    s_mov_b32 s50, 0x300000
    s_mov_b32 s51, 0x20000
    buffer_load_ushort v247, v244, s[76:79], 0 offen
    buffer_load_dwordx4 v[64:67], v245, s[48:51], 0 offen nt
    s_mov_b32 s72, 0x6000
    buffer_load_dwordx4 v[68:71], v245, s[48:51], s72 offen nt
    s_mov_b32 s72, 0xc000
    buffer_load_dwordx4 v[72:75], v245, s[48:51], s72 offen nt
    s_mov_b32 s72, 0x12000
    buffer_load_dwordx4 v[76:79], v245, s[48:51], s72 offen nt
    s_cmp_lt_u32 s5, 2
    s_cbranch_scc1 L_t0_27
    ds_read_b128 v[104:107], v189 offset:16896
    ds_read_b128 v[108:111], v189 offset:16960
    ds_read_b128 v[112:115], v189 offset:17024
    ds_read_b128 v[116:119], v189 offset:17088
    s_waitcnt lgkmcnt(0)
    v_mfma_f32_16x16x32_bf16 v[96:99], v[32:35], v[104:107], 0
    v_mfma_f32_16x16x32_bf16 v[96:99], v[36:39], v[108:111], v[96:99]
    v_mfma_f32_16x16x32_bf16 v[96:99], v[40:43], v[112:115], v[96:99]
    v_mfma_f32_16x16x32_bf16 v[96:99], v[44:47], v[116:119], v[96:99]
    s_nop 7
    v_cvt_pk_bf16_f32 v10, v96, v97
    v_cvt_pk_bf16_f32 v11, v98, v99
    v_lshlrev_b32 v96, 16, v10
    v_and_b32 v97, s65, v10
    v_lshlrev_b32 v98, 16, v11
    v_and_b32 v99, s65, v11
    v_pk_mul_f32 v[96:97], v[96:97], v[200:201] op_sel_hi:[1,0]
    v_pk_mul_f32 v[98:99], v[98:99], v[200:201] op_sel_hi:[1,0]
    v_cvt_pk_bf16_f32 v10, v96, v97
    v_cvt_pk_bf16_f32 v11, v98, v99
    v_lshlrev_b32 v96, 16, v10
    v_and_b32 v97, s65, v10
    v_lshlrev_b32 v98, 16, v11
    v_and_b32 v99, s65, v11
    v_max3_f32 v14, v96, v97, v98
    v_max_f32 v14, v14, v99
    v_mov_b32 v15, v14
    s_nop 1
    v_permlane16_swap_b32 v14, v15
    v_max_f32 v14, v14, v15
    v_mov_b32 v15, v14
    s_nop 1
    v_permlane32_swap_b32 v14, v15
    v_max_f32 v14, v14, v15
    v_mul_f32 v204, s66, v14
    v_pk_fma_f32 v[96:97], v[96:97], v[202:203], v[204:205] op_sel_hi:[1,0,0] neg_lo:[0,0,1] neg_hi:[0,0,1]
    v_pk_fma_f32 v[98:99], v[98:99], v[202:203], v[204:205] op_sel_hi:[1,0,0] neg_lo:[0,0,1] neg_hi:[0,0,1]
    v_exp_f32 v96, v96
    v_exp_f32 v97, v97
    v_exp_f32 v98, v98
    v_exp_f32 v99, v99
    s_nop 0
    v_pk_add_f32 v[16:17], v[96:97], v[98:99]
    v_cvt_pk_bf16_f32 v96, v96, v96
    v_and_b32 v210, v96, v8
    v_and_b32 v211, v96, v9
    v_add_f32 v15, v16, v17
    v_cvt_pk_bf16_f32 v97, v97, v97
    v_mfma_f32_16x16x32_bf16 v[104:107], v[210:213], v[128:131], 0
    v_mfma_f32_16x16x32_bf16 v[108:111], v[208:211], v[128:131], 0
    v_and_b32 v214, v97, v8
    v_and_b32 v215, v97, v9
    v_mov_b32 v16, v15
    v_cvt_pk_bf16_f32 v98, v98, v98
    v_mfma_f32_16x16x32_bf16 v[104:107], v[214:217], v[132:135], v[104:107]
    v_permlane16_swap_b32 v15, v16
    v_mfma_f32_16x16x32_bf16 v[108:111], v[212:215], v[132:135], v[108:111]
    v_and_b32 v218, v98, v8
    v_and_b32 v219, v98, v9
    v_add_f32 v15, v15, v16
    v_mov_b32 v16, v15
    v_cvt_pk_bf16_f32 v99, v99, v99
    v_mfma_f32_16x16x32_bf16 v[104:107], v[218:221], v[136:139], v[104:107]
    v_mfma_f32_16x16x32_bf16 v[108:111], v[216:219], v[136:139], v[108:111]
    v_and_b32 v222, v99, v8
    v_and_b32 v223, v99, v9
    v_permlane32_swap_b32 v15, v16
    v_add_f32 v15, v15, v16
    v_mfma_f32_16x16x32_bf16 v[104:107], v[222:225], v[140:143], v[104:107]
    v_mfma_f32_16x16x32_bf16 v[108:111], v[220:223], v[140:143], v[108:111]
    s_branch L_tj_28
L_t0_27:
    v_mov_b32 v14, 0xff800000
    v_mov_b32 v15, 0
    s_nop 3
    v_mov_b32 v104, 0
    v_mov_b32 v105, 0
    v_mov_b32 v106, 0
    v_mov_b32 v107, 0
    v_mov_b32 v108, 0
    v_mov_b32 v109, 0
    v_mov_b32 v110, 0
    v_mov_b32 v111, 0
L_tj_28:
    ds_write_b32 v199, v14
    ds_write_b32 v199, v15 offset:128
    ds_write_b128 v206, v[104:107]
    ds_write_b128 v206, v[108:111] offset:16
    s_waitcnt lgkmcnt(0)
    s_barrier
    ds_read_b32 v31, v250
    ds_read_b128 v[16:19], v207
    ds_read_b128 v[20:23], v207 offset:16
    ds_read2_b32 v[24:25], v243 offset0:0 offset1:4
    ds_read2_b32 v[26:27], v243 offset0:32 offset1:36
    ds_read_b128 v[32:35], v242
    ds_read_b128 v[36:39], v242 offset:8448
    s_waitcnt lgkmcnt(2)
    v_max3_f32 v112, v16, v17, v18
    v_max3_f32 v113, v19, v20, v21
    v_max3_f32 v112, v112, v22, v23
    v_max_f32 v112, v112, v113
    v_sub_f32 v24, v24, v112
    v_sub_f32 v25, v25, v112
    v_mul_f32 v24, s66, v24
    v_mul_f32 v25, s66, v25
    v_exp_f32 v24, v24
    v_exp_f32 v25, v25
    v_mul_f32 v113, v24, v26
    v_fmac_f32 v113, v25, v27
    v_mov_b32 v114, 0
    v_readfirstlane_b32 s14, v31
    v_add_f32_dpp v113, v113, v113 quad_perm:[1,0,3,2] row_mask:0xf bank_mask:0xf
    v_and_or_b32 v44, v112, v3, s61
    v_and_or_b32 v46, v114, v3, s63
    v_add_f32_dpp v113, v113, v113 quad_perm:[2,3,0,1] row_mask:0xf bank_mask:0xf
    v_and_or_b32 v45, v113, v3, s62
    v_and_or_b32 v47, v114, v3, s64
    s_waitcnt lgkmcnt(0)
    v_mul_f32 v116, v24, v32
    v_mul_f32 v117, v24, v33
    v_mul_f32 v118, v24, v34
    v_mul_f32 v119, v24, v35
    v_fmac_f32 v116, v25, v36
    v_fmac_f32 v117, v25, v37
    v_fmac_f32 v118, v25, v38
    v_fmac_f32 v119, v25, v39
    v_add_f32_dpp v116, v116, v116 quad_perm:[1,0,3,2] row_mask:0xf bank_mask:0xf
    v_add_f32_dpp v117, v117, v117 quad_perm:[1,0,3,2] row_mask:0xf bank_mask:0xf
    v_add_f32_dpp v118, v118, v118 quad_perm:[1,0,3,2] row_mask:0xf bank_mask:0xf
    v_add_f32_dpp v119, v119, v119 quad_perm:[1,0,3,2] row_mask:0xf bank_mask:0xf
    v_add_f32_dpp v116, v116, v116 quad_perm:[2,3,0,1] row_mask:0xf bank_mask:0xf
    v_add_f32_dpp v117, v117, v117 quad_perm:[2,3,0,1] row_mask:0xf bank_mask:0xf
    v_add_f32_dpp v118, v118, v118 quad_perm:[2,3,0,1] row_mask:0xf bank_mask:0xf
    v_add_f32_dpp v119, v119, v119 quad_perm:[2,3,0,1] row_mask:0xf bank_mask:0xf
    v_and_or_b32 v40, v116, v3, s61
    v_and_or_b32 v41, v117, v3, s62
    v_and_or_b32 v42, v118, v3, s63
    v_and_or_b32 v43, v119, v3, s64
    s_cmp_eq_u32 s14, 0
    s_cbranch_scc1 L_aslow_29
    s_mov_b64 exec, s[100:101]
    buffer_store_dwordx4 v[40:43], v248, s[44:47], 0 offen
    s_mov_b64 exec, 1
    buffer_store_dwordx4 v[44:47], v249, s[44:47], 0 offen
    s_mov_b64 exec, -1
    s_branch L_adone_30
L_aslow_29:
    s_mov_b64 exec, s[100:101]
    buffer_store_dwordx4 v[40:43], v248, s[44:47], 0 offen sc1
    s_mov_b64 exec, 1
    buffer_store_dwordx4 v[44:47], v249, s[44:47], 0 offen sc1
    s_mov_b64 exec, -1
L_adone_30:
    s_branch L_M2
L_O:
    s_barrier
    s_mov_b32 s68, 0
L_e2o_33:
    buffer_load_dwordx4 v[96:99], v186, s[44:47], 0 offen sc1
    s_waitcnt vmcnt(0)
    v_xor_b32 v96, s61, v96
    v_xor_b32 v97, s62, v97
    v_xor_b32 v98, s63, v98
    v_xor_b32 v99, s64, v99
    v_or3_b32 v24, v96, v97, v98
    v_or_b32 v24, v24, v99
    v_and_b32 v24, 0xff, v24
    v_cmp_ne_u32 s[70:71], 0, v24
    s_nop 0
    s_cmp_eq_u64 s[70:71], 0
    s_cbranch_scc1 L_e2o_ok_35
L_e2o_r_34:
    s_add_u32 s68, s68, 1
    s_cmp_lt_u32 s68, 32768
    s_cbranch_scc1 L_e2o_33
    s_branch L_end
L_e2o_ok_35:
    s_mov_b32 s52, s24
    s_mov_b32 s53, s25
    s_mov_b32 s54, 0x400000
    s_mov_b32 s55, 0x20000
    buffer_load_dwordx4 v[96:99], v144, s[52:55], 0 offen nt
    s_mov_b32 s72, 0x1000
    buffer_load_dwordx4 v[100:103], v144, s[52:55], s72 offen nt
    s_mov_b32 s72, 0x2000
    buffer_load_dwordx4 v[104:107], v144, s[52:55], s72 offen nt
    s_mov_b32 s72, 0x3000
    buffer_load_dwordx4 v[108:111], v144, s[52:55], s72 offen nt
    s_waitcnt vmcnt(0)
    s_mov_b32 s72, 0x4000
    buffer_load_dwordx4 v[112:115], v144, s[52:55], s72 offen nt
    s_mov_b32 s72, 0x5000
    buffer_load_dwordx4 v[116:119], v144, s[52:55], s72 offen nt
    s_mov_b32 s72, 0x6000
    buffer_load_dwordx4 v[120:123], v144, s[52:55], s72 offen nt
    s_mov_b32 s72, 0x7000
    buffer_load_dwordx4 v[124:127], v144, s[52:55], s72 offen nt
    s_mov_b32 s68, 0
L_e3_36:
    buffer_load_dwordx4 v[48:51], v146, s[44:47], 0 offen sc1
    buffer_load_dwordx4 v[32:35], v145, s[44:47], 0 offen sc1
    buffer_load_dwordx4 v[36:39], v145, s[44:47], 0 offen offset:1024 sc1
    buffer_load_dwordx4 v[40:43], v145, s[44:47], 0 offen offset:2048 sc1
    s_waitcnt vmcnt(0)
    v_xor_b32 v48, s61, v48
    v_xor_b32 v32, s61, v32
    v_xor_b32 v36, s61, v36
    v_xor_b32 v40, s61, v40
    v_or3_b32 v24, v48, v32, v36
    v_or_b32 v24, v24, v40
    v_and_b32 v25, 0xff, v24
    v_cmp_ne_u32 vcc, 0, v25
    s_nop 0
    s_cbranch_vccnz L_e3_r_37
    v_xor_b32 v49, s62, v49
    v_xor_b32 v50, s63, v50
    v_xor_b32 v51, s64, v51
    v_xor_b32 v33, s62, v33
    v_xor_b32 v34, s63, v34
    v_or3_b32 v24, v49, v50, v51
    v_xor_b32 v35, s64, v35
    v_or3_b32 v24, v33, v34, v24
    v_xor_b32 v37, s62, v37
    v_xor_b32 v38, s63, v38
    v_or_b32 v24, v24, v35
    v_xor_b32 v39, s64, v39
    v_or3_b32 v24, v37, v38, v24
    v_xor_b32 v41, s62, v41
    v_xor_b32 v42, s63, v42
    v_or_b32 v24, v24, v39
    v_xor_b32 v43, s64, v43
    v_or3_b32 v24, v41, v42, v24
    v_or_b32 v24, v24, v43
    v_and_b32 v24, 0xff, v24
    v_cmp_ne_u32 vcc, 0, v24
    s_nop 0
    s_cbranch_vccz L_e3_ok_38
L_e3_r_37:
    s_add_u32 s68, s68, 1
    s_cmp_lt_u32 s68, 32768
    s_cbranch_scc1 L_e3_36
    s_branch L_end
L_e3_ok_38:
    v_add_f32 v48, v48, v148
    v_mov_b32 v22, v48
    s_nop 1
    v_max_f32_dpp v22, v22, v22 quad_perm:[1,0,3,2] row_mask:0xf bank_mask:0xf
    s_nop 1
    v_max_f32_dpp v22, v22, v22 quad_perm:[2,3,0,1] row_mask:0xf bank_mask:0xf
    s_nop 1
    v_max_f32_dpp v22, v22, v22 row_ror:8 row_mask:0xf bank_mask:0xf
    v_mov_b32 v23, v22
    s_nop 1
    v_permlane16_swap_b32 v22, v23
    v_max_f32 v22, v22, v23
    v_mov_b32 v23, v22
    s_nop 1
    v_permlane32_swap_b32 v22, v23
    v_max_f32 v22, v22, v23
    v_sub_f32 v26, v48, v22
    v_mul_f32 v26, s66, v26
    v_exp_f32 v26, v26
    s_nop 0
    v_mul_f32 v23, v26, v49
    v_mov_b32_dpp v52, v26 quad_perm:[0,0,0,0] row_mask:0xf bank_mask:0xf
    v_mov_b32_dpp v53, v26 quad_perm:[1,1,1,1] row_mask:0xf bank_mask:0xf
    v_add_f32_dpp v23, v23, v23 quad_perm:[1,0,3,2] row_mask:0xf bank_mask:0xf
    v_mul_f32 v32, v32, v52
    v_mul_f32 v33, v33, v52
    v_add_f32_dpp v23, v23, v23 quad_perm:[2,3,0,1] row_mask:0xf bank_mask:0xf
    v_mul_f32 v34, v34, v52
    v_mul_f32 v35, v35, v52
    v_mov_b32_dpp v54, v26 quad_perm:[2,2,2,2] row_mask:0xf bank_mask:0xf
    v_add_f32_dpp v23, v23, v23 row_ror:8 row_mask:0xf bank_mask:0xf
    v_fmac_f32 v32, v36, v53
    v_fmac_f32 v33, v37, v53
    v_fmac_f32 v34, v38, v53
    v_fmac_f32 v35, v39, v53
    v_mov_b32 v24, v23
    v_fmac_f32 v32, v40, v54
    v_fmac_f32 v33, v41, v54
    v_fmac_f32 v34, v42, v54
    v_fmac_f32 v35, v43, v54
    v_permlane16_swap_b32 v23, v24
    v_permlane32_swap_b32 v32, v34
    v_permlane32_swap_b32 v33, v35
    v_add_f32 v23, v23, v24
    v_add_f32 v32, v32, v34
    v_add_f32 v33, v33, v35
    v_mov_b32 v24, v23
    s_nop 0
    v_permlane16_swap_b32 v32, v33
    v_permlane32_swap_b32 v23, v24
    v_add_f32 v32, v32, v33
    v_add_f32 v23, v23, v24
    v_rcp_f32 v25, v23
    v_add_f32_dpp v32, v32, v32 row_ror:8 row_mask:0xf bank_mask:0xf
    v_mul_f32 v26, v32, v25
    v_fma_f32 v27, -v26, v23, v32
    v_fma_f32 v26, v27, v25, v26
    v_cvt_pk_bf16_f32 v20, v26, v26
    s_nop 1
    v_mov_b32_dpp v163, v20 row_newbcast:0 row_mask:0xf bank_mask:0xf
    v_and_b32 v160, v163, v4
    v_and_b32 v161, v163, v5
    v_and_b32 v162, v163, v6
    v_and_b32 v163, v163, v7
    v_mov_b32_dpp v167, v20 row_newbcast:1 row_mask:0xf bank_mask:0xf
    v_and_b32 v164, v167, v4
    v_mfma_f32_16x16x32_bf16 v[60:63], v[160:163], v[96:99], 0
    v_and_b32 v165, v167, v5
    v_and_b32 v166, v167, v6
    v_and_b32 v167, v167, v7
    v_mov_b32_dpp v171, v20 row_newbcast:2 row_mask:0xf bank_mask:0xf
    v_and_b32 v168, v171, v4
    v_mfma_f32_16x16x32_bf16 v[60:63], v[164:167], v[100:103], v[60:63]
    v_and_b32 v169, v171, v5
    v_and_b32 v170, v171, v6
    v_and_b32 v171, v171, v7
    v_mov_b32_dpp v175, v20 row_newbcast:3 row_mask:0xf bank_mask:0xf
    v_and_b32 v172, v175, v4
    v_mfma_f32_16x16x32_bf16 v[60:63], v[168:171], v[104:107], v[60:63]
    v_and_b32 v173, v175, v5
    v_and_b32 v174, v175, v6
    v_and_b32 v175, v175, v7
    v_mov_b32_dpp v179, v20 row_newbcast:4 row_mask:0xf bank_mask:0xf
    v_and_b32 v176, v179, v4
    v_mfma_f32_16x16x32_bf16 v[60:63], v[172:175], v[108:111], v[60:63]
    v_and_b32 v177, v179, v5
    v_and_b32 v178, v179, v6
    v_and_b32 v179, v179, v7
    v_mov_b32_dpp v183, v20 row_newbcast:5 row_mask:0xf bank_mask:0xf
    v_and_b32 v180, v183, v4
    v_mfma_f32_16x16x32_bf16 v[60:63], v[176:179], v[112:115], v[60:63]
    v_and_b32 v181, v183, v5
    v_and_b32 v182, v183, v6
    v_and_b32 v183, v183, v7
    v_mov_b32_dpp v187, v20 row_newbcast:6 row_mask:0xf bank_mask:0xf
    v_and_b32 v184, v187, v4
    v_mfma_f32_16x16x32_bf16 v[60:63], v[180:183], v[116:119], v[60:63]
    v_and_b32 v185, v187, v5
    v_and_b32 v186, v187, v6
    v_and_b32 v187, v187, v7
    v_mov_b32_dpp v191, v20 row_newbcast:7 row_mask:0xf bank_mask:0xf
    v_and_b32 v188, v191, v4
    v_mfma_f32_16x16x32_bf16 v[60:63], v[184:187], v[120:123], v[60:63]
    v_and_b32 v189, v191, v5
    v_and_b32 v190, v191, v6
    v_and_b32 v191, v191, v7
    s_nop 1
    v_mfma_f32_16x16x32_bf16 v[60:63], v[188:191], v[124:127], v[60:63]
    s_mov_b32 exec_hi, 0
    s_nop 6
    ds_write_b128 v155, v[60:63]
    s_mov_b64 exec, -1
    s_waitcnt lgkmcnt(0)
    s_barrier
    s_cmp_ge_u32 s5, 2
    s_cbranch_scc1 L_fin
    ds_read_b128 v[64:67], v156 offset:0
    ds_read_b128 v[68:71], v156 offset:2304
    s_waitcnt lgkmcnt(0)
    v_add_f32 v64, v64, v68
    v_add_f32 v65, v65, v69
    v_add_f32 v66, v66, v70
    v_add_f32 v67, v67, v71
    v_add_f32_dpp v64, v64, v64 quad_perm:[1,0,3,2] row_mask:0xf bank_mask:0xf
    v_add_f32_dpp v65, v65, v65 quad_perm:[1,0,3,2] row_mask:0xf bank_mask:0xf
    v_add_f32_dpp v66, v66, v66 quad_perm:[1,0,3,2] row_mask:0xf bank_mask:0xf
    v_add_f32_dpp v67, v67, v67 quad_perm:[1,0,3,2] row_mask:0xf bank_mask:0xf
    v_add_f32_dpp v64, v64, v64 quad_perm:[2,3,0,1] row_mask:0xf bank_mask:0xf
    v_add_f32_dpp v65, v65, v65 quad_perm:[2,3,0,1] row_mask:0xf bank_mask:0xf
    v_add_f32_dpp v66, v66, v66 quad_perm:[2,3,0,1] row_mask:0xf bank_mask:0xf
    v_add_f32_dpp v67, v67, v67 quad_perm:[2,3,0,1] row_mask:0xf bank_mask:0xf
    v_and_or_b32 v16, v64, v3, s61
    v_and_or_b32 v17, v65, v3, s62
    v_and_or_b32 v18, v66, v3, s63
    v_and_or_b32 v19, v67, v3, s64
    s_mov_b64 exec, s[100:101]
    buffer_store_dwordx4 v[16:19], v147, s[44:47], 0 offen sc1
    s_mov_b32 s72, 0x8000
    buffer_store_dwordx4 v[16:19], v147, s[44:47], s72 offen sc1
    s_mov_b32 s72, 0x10000
    buffer_store_dwordx4 v[16:19], v147, s[44:47], s72 offen sc1
    s_mov_b32 s72, 0x18000
    buffer_store_dwordx4 v[16:19], v147, s[44:47], s72 offen sc1
    s_mov_b32 s72, 0x20000
    buffer_store_dwordx4 v[16:19], v147, s[44:47], s72 offen sc1
    s_mov_b32 s72, 0x28000
    buffer_store_dwordx4 v[16:19], v147, s[44:47], s72 offen sc1
    s_mov_b32 s72, 0x30000
    buffer_store_dwordx4 v[16:19], v147, s[44:47], s72 offen sc1
    s_mov_b32 s72, 0x38000
    buffer_store_dwordx4 v[16:19], v147, s[44:47], s72 offen sc1
    s_mov_b64 exec, -1
    s_branch L_fin
L_M2:
    s_waitcnt vmcnt(0)
    v_lshlrev_b32 v247, 16, v247
    v_mul_f32 v22, 0xbfb8aa3b, v247
    v_min_f32 v22, 0x42fc0000, v22
    v_exp_f32 v22, v22
    s_nop 0
    v_add_f32 v22, 1.0, v22
    v_rcp_f32 v30, v22
    s_nop 0
    v_mul_f32 v23, v247, v30
    v_fma_f32 v31, -v23, v22, v247
    v_fma_f32 v23, v31, v30, v23
    v_cvt_pk_bf16_f32 v247, v23, v23
    s_nop 1
    v_mov_b32_dpp v163, v247 row_newbcast:0 row_mask:0xf bank_mask:0xf
    v_and_b32 v160, v163, v4
    v_and_b32 v161, v163, v5
    v_and_b32 v162, v163, v6
    v_and_b32 v163, v163, v7
    v_mov_b32_dpp v167, v247 row_newbcast:1 row_mask:0xf bank_mask:0xf
    v_and_b32 v164, v167, v4
    v_mfma_f32_16x16x32_bf16 v[60:63], v[160:163], v[64:67], 0
    v_and_b32 v165, v167, v5
    v_and_b32 v166, v167, v6
    v_and_b32 v167, v167, v7
    v_mov_b32_dpp v171, v247 row_newbcast:2 row_mask:0xf bank_mask:0xf
    v_and_b32 v168, v171, v4
    v_mfma_f32_16x16x32_bf16 v[60:63], v[164:167], v[68:71], v[60:63]
    v_and_b32 v169, v171, v5
    v_and_b32 v170, v171, v6
    v_and_b32 v171, v171, v7
    v_mov_b32_dpp v175, v247 row_newbcast:3 row_mask:0xf bank_mask:0xf
    v_and_b32 v172, v175, v4
    v_mfma_f32_16x16x32_bf16 v[60:63], v[168:171], v[72:75], v[60:63]
    v_and_b32 v173, v175, v5
    v_and_b32 v174, v175, v6
    v_and_b32 v175, v175, v7
    s_nop 1
    v_mfma_f32_16x16x32_bf16 v[60:63], v[172:175], v[76:79], v[60:63]
    s_mov_b32 exec_hi, 0
    s_nop 6
    ds_write_b128 v155, v[60:63] offset:21248
    s_mov_b64 exec, -1
    s_waitcnt lgkmcnt(0)
    s_barrier
    s_cmp_ge_u32 s5, 2
    s_cbranch_scc1 L_fin
    ds_read_b128 v[80:83], v156 offset:21248
    ds_read_b128 v[84:87], v156 offset:23552
    s_waitcnt lgkmcnt(0)
    v_add_f32 v80, v80, v84
    v_add_f32 v81, v81, v85
    v_add_f32 v82, v82, v86
    v_add_f32 v83, v83, v87
    v_add_f32_dpp v80, v80, v80 quad_perm:[1,0,3,2] row_mask:0xf bank_mask:0xf
    v_add_f32_dpp v81, v81, v81 quad_perm:[1,0,3,2] row_mask:0xf bank_mask:0xf
    v_add_f32_dpp v82, v82, v82 quad_perm:[1,0,3,2] row_mask:0xf bank_mask:0xf
    v_add_f32_dpp v83, v83, v83 quad_perm:[1,0,3,2] row_mask:0xf bank_mask:0xf
    v_add_f32_dpp v80, v80, v80 quad_perm:[2,3,0,1] row_mask:0xf bank_mask:0xf
    v_add_f32_dpp v81, v81, v81 quad_perm:[2,3,0,1] row_mask:0xf bank_mask:0xf
    v_add_f32_dpp v82, v82, v82 quad_perm:[2,3,0,1] row_mask:0xf bank_mask:0xf
    v_add_f32_dpp v83, v83, v83 quad_perm:[2,3,0,1] row_mask:0xf bank_mask:0xf
    v_and_or_b32 v16, v80, v3, s61
    v_and_or_b32 v17, v81, v3, s62
    v_and_or_b32 v18, v82, v3, s63
    v_and_or_b32 v19, v83, v3, s64
    s_mov_b64 exec, s[100:101]
    buffer_store_dwordx4 v[16:19], v246, s[44:47], 0 offen sc1
    s_mov_b64 exec, -1
    s_branch L_fin
L_X:
    s_mul_i32 s7, s4, 208
    s_lshl_b32 s8, s5, 4
    s_add_u32 s7, s7, s8
    s_add_u32 s7, s7, 28672
    s_lshl_b32 s7, s7, 8
    s_lshl_b32 s8, s3, 23
    v_add_u32 v190, 0, v2
    v_add_u32 v191, 4, v2
    v_add_u32 v192, 8, v2
    v_add_u32 v193, 12, v2
    s_add_u32 s12, s7, s8
    v_lshlrev_b32 v10, 8, v2
    v_xor_b32 v190, v190, v1
    v_xor_b32 v191, v191, v1
    v_xor_b32 v192, v192, v1
    v_xor_b32 v193, v193, v1
    v_lshlrev_b32 v11, 10, v2
    v_lshlrev_b32 v12, 4, v1
    v_add_u32 v10, s12, v10
    v_lshlrev_b32 v190, 4, v190
    v_lshlrev_b32 v191, 4, v191
    v_lshlrev_b32 v192, 4, v192
    v_lshlrev_b32 v193, 4, v193
    s_lshl_b32 s13, s5, 12
    v_add_u32 v11, v11, v12
    s_mov_b32 s6, s4
    s_mov_b32 s48, s18
    s_mov_b32 s49, s19
    s_mov_b32 s50, 0x4000000
    s_mov_b32 s51, 0x20000
    s_mov_b32 s52, s20
    s_mov_b32 s53, s21
    s_mov_b32 s54, 0x4000000
    s_mov_b32 s55, 0x20000
    v_add_u32 v190, v190, v10
    v_add_u32 v191, v191, v10
    v_add_u32 v192, v192, v10
    v_add_u32 v193, v193, v10
    s_add_u32 s13, s13, 21248
    v_add_u32 v198, s12, v11
    s_waitcnt lgkmcnt(0)
    s_add_u32 s69, s67, 1
    s_mul_i32 s60, s69, 0x9E3779B1
    s_xor_b32 s60, s60, 0x5BD1E995
    s_lshl_b32 s11, s2, 7
    s_and_b32 s61, s60, 0xff
    s_bfe_u32 s62, s60, 0x80008
    s_bfe_u32 s63, s60, 0x80010
    s_lshr_b32 s64, s60, 24
    s_add_u32 s11, s11, 0x8000
    s_cmp_lg_u32 s5, 2
    s_cbranch_scc1 L_nofl_39
    s_or_b32 s7, s15, s61
    v_mov_b32 v16, s7
    v_mov_b32 v17, s62
    v_mov_b32 v18, s63
    v_mov_b32 v19, s64
    v_mov_b32 v20, s11
    s_mov_b64 exec, 1
    buffer_store_dwordx4 v[16:19], v20, s[44:47], 0 offen sc1
    s_mov_b64 exec, -1
L_nofl_39:
    s_lshr_b32 s8, s5, 1
    s_lshl_b32 s10, s3, 2
    s_and_b32 s9, s5, 1
    s_add_u32 s10, s10, s8
    s_lshl_b32 s11, s10, 11
    s_lshl_b32 s7, s9, 8
    s_add_u32 s11, s11, s7
    v_lshlrev_b32 v12, 9, v2
    v_lshlrev_b32 v13, 4, v1
    s_add_u32 s11, s11, 0x10000
    v_add_u32 v12, v12, v13
    v_add_u32 v186, s11, v12
    v_lshrrev_b32 v14, 2, v0
    s_lshl_b32 s11, s5, 4
    v_and_b32 v15, 3, v0
    v_add_u32 v16, s11, v14
    v_lshlrev_b32 v16, 4, v16
    v_mul_u32_u24 v17, 2112, v15
    v_add_u32 v242, v16, v17
    s_lshl_b32 s11, s8, 5
    s_add_u32 s11, s11, 17920
    v_lshlrev_b32 v17, 2, v15
    v_mov_b32 v207, s11
    v_add_u32 v243, s11, v17
    s_lshl_b32 s11, s10, 2
    s_lshl_b32 s7, s9, 1
    v_and_b32 v10, 1, v1
    s_add_u32 s11, s11, s7
    v_lshlrev_b32 v10, 4, v10
    v_mov_b32 v11, 0xffff
    s_mov_b32 s99, s4
    s_lshl_b32 s11, s11, 5
    v_lshlrev_b32 v10, v10, v11
    s_add_u32 s11, s11, s99
    v_lshrrev_b32 v11, 1, v1
    s_lshl_b32 s7, s11, 7
    v_cmp_eq_u32 vcc, 0, v11
    v_lshrrev_b32 v16, 3, v14
    v_and_b32 v17, 7, v14
    s_lshl_b32 s11, s10, 1
    v_lshlrev_b32 v16, 12, v16
    v_lshlrev_b32 v17, 4, v17
    s_add_u32 s11, s11, s9
    s_add_u32 s7, s7, 0x180000
    v_add_u32 v16, v16, v17
    s_lshl_b32 s11, s11, 5
    v_cndmask_b32 v4, 0, v10, vcc
    v_add_u32 v248, s7, v16
    s_add_u32 s11, s11, s99
    v_cmp_eq_u32 vcc, 1, v11
    s_lshl_b32 s7, s11, 4
    s_lshl_b32 s10, s8, 8
    s_lshl_b32 s11, s9, 7
    s_add_u32 s10, s10, s11
    v_lshlrev_b32 v12, 3, v1
    v_lshlrev_b32 v14, 1, v2
    v_cndmask_b32 v5, 0, v10, vcc
    s_add_u32 s10, s10, 16896
    v_add_u32 v12, v12, v14
    v_cmp_eq_u32 vcc, 2, v11
    v_add_u32 v188, s10, v12
    v_lshrrev_b32 v12, 2, v1
    v_lshlrev_b32 v14, 8, v12
    v_lshlrev_b32 v15, 4, v2
    v_cndmask_b32 v6, 0, v10, vcc
    v_add_u32 v189, v14, v15
    v_add_u32 v194, 0, v2
    v_add_u32 v195, 4, v2
    v_add_u32 v196, 8, v2
    v_add_u32 v197, 12, v2
    v_cmp_eq_u32 vcc, 3, v11
    v_lshlrev_b32 v14, 8, v1
    v_xor_b32 v194, v194, v1
    v_xor_b32 v195, v195, v1
    v_xor_b32 v196, v196, v1
    v_xor_b32 v197, v197, v1
    v_add_u32 v14, s13, v14
    v_lshlrev_b32 v194, 4, v194
    v_lshlrev_b32 v195, 4, v195
    v_lshlrev_b32 v196, 4, v196
    v_lshlrev_b32 v197, 4, v197
    v_add_u32 v194, v194, v14
    v_add_u32 v195, v195, v14
    v_add_u32 v196, v196, v14
    v_add_u32 v197, v197, v14
    s_lshl_b32 s10, s5, 2
    v_cndmask_b32 v7, 0, v10, vcc
    v_and_b32 v11, 1, v11
    s_add_u32 s7, s7, 0x20000
    v_lshlrev_b32 v14, 5, v12
    s_add_u32 s10, s10, 17920
    v_cmp_eq_u32 vcc, 0, v11
    v_mov_b32 v249, s7
    v_add_u32 v199, s10, v14
    v_and_b32 v187, 31, v0
    s_lshl_b32 s7, s3, 7
    v_lshlrev_b32 v14, 9, v2
    v_lshlrev_b32 v15, 5, v1
    v_lshlrev_b32 v187, 10, v187
    s_add_u32 s7, s7, 0x8000
    v_add_u32 v14, v14, v15
    s_mul_i32 s10, s5, 2112
    v_mov_b32 v3, 0xffffff00
    v_cndmask_b32 v8, 0, v10, vcc
    v_cndmask_b32 v9, v10, 0, vcc
    v_mov_b32 v200, 0x3db504f3
    v_mov_b32 v202, 0x3fb8aa3b
    v_mov_b32 v208, 0
    v_mov_b32 v209, 0
    v_mov_b32 v212, 0
    v_mov_b32 v213, 0
    v_mov_b32 v216, 0
    v_mov_b32 v217, 0
    v_mov_b32 v220, 0
    v_mov_b32 v221, 0
    v_mov_b32 v224, 0
    v_mov_b32 v225, 0
    v_mov_b32 v228, 0
    v_mov_b32 v229, 0
    v_mov_b32 v232, 0
    v_mov_b32 v233, 0
    v_mov_b32 v236, 0
    v_mov_b32 v237, 0
    v_mov_b32 v240, 0
    v_mov_b32 v241, 0
    v_add_u32 v187, s7, v187
    v_add_u32 v206, s10, v14
    v_mov_b32 v250, 21120
    s_cmp_eq_u32 s3, 7
    s_cbranch_scc1 L_Zpre
    s_lshr_b32 s8, s6, 3
    s_lshl_b32 s9, s3, 1
    s_add_u32 s8, s8, s9
    s_and_b32 s9, s6, 7
    s_lshl_b32 s10, s9, 6
    s_lshl_b32 s11, s5, 3
    s_add_u32 s10, s10, s11
    v_mul_u32_u24 v12, 3584, v2
    s_mul_i32 s11, s10, 3584
    s_lshl_b32 s7, s8, 8
    v_add_u32 v12, v12, v13
    s_add_u32 s11, s11, s7
    v_add_u32 v183, s11, v12
    s_lshl_b32 s11, s8, 7
    s_lshl_b32 s7, s9, 4
    s_add_u32 s11, s11, s7
    v_lshlrev_b32 v12, 10, v2
    s_lshl_b32 s11, s11, 10
    s_lshl_b32 s7, s5, 8
    v_add_u32 v12, v12, v13
    s_add_u32 s11, s11, s7
    v_add_u32 v184, s11, v12
    s_lshl_b32 s11, s5, 4
    v_add_u32 v14, s11, v1
    v_lshrrev_b32 v16, 5, v14
    v_lshlrev_b32 v16, 2, v16
    v_add_u32 v16, v16, v2
    v_lshlrev_b32 v16, 5, v16
    v_and_b32 v17, 31, v14
    v_add_u32 v16, v16, v17
    v_lshlrev_b32 v16, 4, v16
    v_add_u32 v172, 0x90000, v16
    s_lshl_b32 s11, s9, 4
    s_lshl_b32 s7, s5, 1
    s_add_u32 s11, s11, s7
    v_and_b32 v16, 1, v1
    v_lshrrev_b32 v17, 1, v1
    v_add_u32 v16, s11, v16
    v_and_b32 v17, 1, v17
    v_lshlrev_b32 v17, 2, v17
    v_lshrrev_b32 v18, 5, v16
    v_add3_u32 v17, v17, v18, 4
    v_lshlrev_b32 v17, 2, v17
    v_add_u32 v17, v17, v2
    v_lshlrev_b32 v17, 5, v17
    v_and_b32 v16, 31, v16
    v_add_u32 v17, v17, v16
    v_lshlrev_b32 v17, 4, v17
    v_add_u32 v173, 0x90000, v17
    v_lshlrev_b32 v16, 11, v2
    v_lshlrev_b32 v17, 4, v14
    s_lshl_b32 s7, s3, 15
    v_add_u32 v16, v16, v17
    s_add_u32 s7, s7, 0xa0000
    v_add_u32 v174, s7, v16
    s_lshl_b32 s11, s5, 8
    s_add_u32 s11, s11, 240
    s_lshl_b32 s7, s3, 12
    s_add_u32 s11, s11, s7
    s_lshl_b32 s7, s3, 15
    v_and_b32 v16, 1, v0
    s_add_u32 s11, s11, s7
    v_lshlrev_b32 v16, 11, v16
    s_add_u32 s11, s11, 0xa0000
    v_add_u32 v185, s11, v16
    v_and_b32 v16, 1, v1
    v_lshlrev_b32 v16, 2, v16
    v_add_u32 v16, v16, v2
    v_add_u32 v16, s10, v16
    s_lshl_b32 s7, s5, 3
    v_lshlrev_b32 v177, 2, v16
    s_add_u32 s7, s7, 21136
    v_lshlrev_b32 v16, 1, v1
    v_mov_b32 v176, s7
    s_and_b32 s11, s5, 1
    v_add_u32 v16, v16, v2
    s_lshl_b32 s11, s11, 4
    v_lshlrev_b32 v16, 4, v16
    s_mul_i32 s7, s5, 576
    v_lshrrev_b32 v18, 2, v0
    v_add_u32 v178, s7, v16
    v_and_b32 v17, 3, v0
    v_add_u32 v18, s11, v18
    v_mul_u32_u24 v17, 576, v17
    v_lshlrev_b32 v18, 4, v18
    s_lshr_b32 s7, s5, 1
    v_add_u32 v179, v17, v18
    s_mul_i32 s7, s7, 4608
    v_add_u32 v179, s7, v179
    s_lshl_b32 s7, s8, 3
    s_add_u32 s7, s7, s9
    s_lshl_b32 s11, s7, 10
    v_lshrrev_b32 v16, 2, v0
    s_add_u32 s11, s11, 0x30000
    v_lshlrev_b32 v16, 4, v16
    v_add_u32 v180, s11, v16
    s_lshl_b32 s11, s5, 8
    v_add_u32 v180, s11, v180
    s_lshl_b32 s11, s7, 11
    v_lshlrev_b32 v16, 1, v1
    s_lshl_b32 s7, s5, 9
    v_add_u32 v16, v16, v2
    s_add_u32 s11, s11, s7
    v_lshlrev_b32 v16, 4, v16
    s_add_u32 s11, s11, 0x50000
    v_add_u32 v182, s11, v16
    v_lshrrev_b32 v17, 2, v0
    v_lshrrev_b32 v16, 3, v0
    v_and_b32 v17, 1, v17
    v_lshlrev_b32 v16, 10, v16
    v_lshlrev_b32 v17, 9, v17
    v_add_u32 v16, v16, v17
    v_and_b32 v17, 3, v0
    s_lshl_b32 s7, s8, 13
    s_lshl_b32 s11, s9, 6
    v_lshlrev_b32 v17, 4, v17
    s_add_u32 s7, s7, s11
    v_lshlrev_b32 v15, 2, v14
    v_add_u32 v16, v16, v17
    s_add_u32 s7, s7, 0x30000
    v_add_u32 v15, v15, v2
    v_add_u32 v181, s7, v16
    v_lshlrev_b32 v171, 1, v15
    v_lshlrev_b32 v175, 2, v15
    buffer_load_dwordx4 v[244:247], v181, s[44:47], 0 offen sc1
    s_mov_b32 s56, s28
    s_mov_b32 s57, s29
    s_mov_b32 s58, 0x1c0000
    s_mov_b32 s59, 0x20000
    s_mov_b32 s76, s30
    s_mov_b32 s77, s31
    s_mov_b32 s78, 0x1c0000
    s_mov_b32 s79, 0x20000
    s_mov_b64 exec, 1
    buffer_load_dword v251, v183, s[56:59], 0 offen
    buffer_load_dword v251, v183, s[76:79], 0 offen
    s_mov_b32 s56, s32
    s_mov_b32 s57, s33
    s_mov_b32 s58, 0x1c0000
    s_mov_b32 s59, 0x20000
    buffer_load_dword v251, v184, s[56:59], 0 offen
    s_mov_b64 exec, -1
    s_branch L_Xgo
L_Zpre:
    v_and_b32 v12, 7, v0
    s_lshl_b32 s8, s6, 3
    v_lshrrev_b32 v11, 3, v0
    v_add_u32 v14, s8, v12
    v_lshlrev_b32 v15, 4, v14
    v_lshlrev_b32 v16, 11, v11
    s_lshl_b32 s9, s5, 15
    v_add_u32 v16, v16, v15
    s_add_u32 s9, s9, 0x50000
    v_add_u32 v172, s9, v16
    v_lshlrev_b32 v17, 4, v12
    v_lshlrev_b32 v18, 2, v2
    v_add_u32 v175, v17, v18
    s_lshl_b32 s9, s5, 7
    v_add_u32 v176, s9, v175
    v_lshlrev_b32 v17, 2, v12
    v_add_u32 v17, v17, v2
    s_lshl_b32 s9, s6, 5
    v_add_u32 v17, s9, v17
    v_lshlrev_b32 v171, 1, v17
    v_and_b32 v177, 1, v11
    v_lshrrev_b32 v17, 5, v14
    v_mul_u32_u24 v18, 12, v177
    v_add_u32 v17, v17, v18
    v_lshlrev_b32 v17, 2, v17
    v_add_u32 v17, v17, v2
    v_lshlrev_b32 v17, 5, v17
    v_and_b32 v18, 31, v14
    v_add_u32 v17, v17, v18
    v_lshlrev_b32 v17, 4, v17
    v_add_u32 v174, 0xd8000, v16
    v_add_u32 v173, 0x90000, v17
    v_mov_b32 v178, 0
    v_mov_b32 v179, 0
    v_mov_b32 v180, 0
    v_mov_b32 v181, 0
    v_mov_b32 v182, 0
    v_mov_b32 v183, 0
    v_mov_b32 v184, 0
    v_mov_b32 v185, 0
L_Xgo:
    s_mov_b32 m0, s13
    s_cmp_ge_u32 s5, 5
    buffer_load_dwordx4 v190, s[48:51], 0 offen nt lds
    buffer_load_dwordx4 v191, s[48:51], 0 offen offset:1024 nt lds
    buffer_load_dwordx4 v192, s[48:51], 0 offen offset:2048 nt lds
    buffer_load_dwordx4 v193, s[48:51], 0 offen offset:3072 nt lds
    s_cbranch_scc1 L_onet_41
    s_add_u32 m0, s13, 0x8000
    s_mov_b32 s73, 0x8000
    buffer_load_dwordx4 v190, s[48:51], s73 offen nt lds
    buffer_load_dwordx4 v191, s[48:51], s73 offen offset:1024 nt lds
    buffer_load_dwordx4 v192, s[48:51], s73 offen offset:2048 nt lds
    buffer_load_dwordx4 v193, s[48:51], s73 offen offset:3072 nt lds
    buffer_load_dwordx4 v[144:147], v198, s[52:55], s73 offen nt
    buffer_load_dwordx4 v[148:151], v198, s[52:55], s73 offen offset:256 nt
    buffer_load_dwordx4 v[152:155], v198, s[52:55], s73 offen offset:512 nt
    buffer_load_dwordx4 v[156:159], v198, s[52:55], s73 offen offset:768 nt
L_onet_41:
    buffer_load_dwordx4 v[128:131], v198, s[52:55], 0 offen nt
    buffer_load_dwordx4 v[132:135], v198, s[52:55], 0 offen offset:256 nt
    buffer_load_dwordx4 v[136:139], v198, s[52:55], 0 offen offset:512 nt
    buffer_load_dwordx4 v[140:143], v198, s[52:55], 0 offen offset:768 nt
L_nold_40:
    s_cmp_ge_u32 s5, 5
    s_cbranch_scc1 L_kf1_42
    s_waitcnt vmcnt(8)
    ds_read_b128 v[48:51], v194 offset:32768
    ds_read_b128 v[52:55], v195 offset:32768
    ds_read_b128 v[56:59], v196 offset:32768
    ds_read_b128 v[60:63], v197 offset:32768
    s_branch L_kf2_43
L_kf1_42:
    s_waitcnt vmcnt(4)
L_kf2_43:
    ds_read_b128 v[32:35], v194
    ds_read_b128 v[36:39], v195
    ds_read_b128 v[40:43], v196
    ds_read_b128 v[44:47], v197
    s_cmp_eq_u32 s5, 7
    s_cbranch_scc1 L_p7_44
    s_mov_b32 s68, 0
L_e2_46:
    buffer_load_dwordx4 v[96:99], v186, s[44:47], 0 offen sc1
    s_waitcnt vmcnt(0)
    v_xor_b32 v96, s61, v96
    v_xor_b32 v97, s62, v97
    v_xor_b32 v98, s63, v98
    v_xor_b32 v99, s64, v99
    v_or3_b32 v24, v96, v97, v98
    v_or_b32 v24, v24, v99
    v_and_b32 v24, 0xff, v24
    v_cmp_ne_u32 s[70:71], 0, v24
    s_nop 0
    s_cmp_eq_u64 s[70:71], 0
    s_cbranch_scc1 L_e2_ok_48
L_e2_r_47:
    s_add_u32 s68, s68, 1
    s_cmp_lt_u32 s68, 32768
    s_cbranch_scc1 L_e2_46
    s_branch L_end
L_e2_ok_48:
    s_branch L_pd_45
L_p7_44:
    s_mov_b32 s68, 0
L_e2x_49:
    buffer_load_dwordx4 v[96:99], v186, s[44:47], 0 offen sc1
    buffer_load_dwordx4 v[100:103], v187, s[44:47], 0 offen sc1
    s_waitcnt vmcnt(0)
    v_xor_b32 v96, s61, v96
    v_xor_b32 v100, s61, v100
    v_or_b32 v24, v96, v100
    v_and_b32 v25, 0xff, v24
    v_cmp_ne_u32 vcc, 0, v25
    s_nop 0
    s_cbranch_vccnz L_e2x_r_50
    v_xor_b32 v97, s62, v97
    v_xor_b32 v98, s63, v98
    v_xor_b32 v99, s64, v99
    v_xor_b32 v101, s62, v101
    v_xor_b32 v102, s63, v102
    v_or3_b32 v24, v97, v98, v99
    v_xor_b32 v103, s64, v103
    v_or3_b32 v24, v101, v102, v24
    v_or_b32 v24, v24, v103
    v_and_b32 v24, 0xff, v24
    v_cmp_ne_u32 vcc, 0, v24
    s_nop 0
    s_cbranch_vccz L_e2x_ok_51
L_e2x_r_50:
    s_add_u32 s68, s68, 1
    s_cmp_lt_u32 s68, 32768
    s_cbranch_scc1 L_e2x_49
    s_branch L_end
L_e2x_ok_51:
    v_cmp_ne_u32 vcc, s15, v100
    v_mov_b32 v25, 21120
    s_cmp_eq_u64 vcc, 0
    s_cselect_b32 s7, 1, 0
    v_mov_b32 v24, s7
    ds_write_b32 v25, v24
L_pd_45:
    v_permlane32_swap_b32 v96, v98
    v_permlane32_swap_b32 v97, v99
    v_add_f32 v96, v96, v98
    v_add_f32 v97, v97, v99
    s_nop 1
    v_permlane16_swap_b32 v96, v97
    v_add_f32 v96, v96, v97
    v_cvt_pk_bf16_f32 v96, v96, v96
    ds_write_b16 v188, v96
    s_waitcnt lgkmcnt(0)
    s_barrier
    ds_read_b128 v[104:107], v189 offset:16896
    ds_read_b128 v[108:111], v189 offset:16960
    ds_read_b128 v[112:115], v189 offset:17024
    ds_read_b128 v[116:119], v189 offset:17088
    s_waitcnt lgkmcnt(0)
    s_cmp_ge_u32 s5, 5
    s_cbranch_scc1 L_t1_52
    v_mfma_f32_16x16x32_bf16 v[96:99], v[32:35], v[104:107], 0
    v_mfma_f32_16x16x32_bf16 v[100:103], v[48:51], v[104:107], 0
    v_mfma_f32_16x16x32_bf16 v[96:99], v[36:39], v[108:111], v[96:99]
    v_mfma_f32_16x16x32_bf16 v[100:103], v[52:55], v[108:111], v[100:103]
    v_mfma_f32_16x16x32_bf16 v[96:99], v[40:43], v[112:115], v[96:99]
    v_mfma_f32_16x16x32_bf16 v[100:103], v[56:59], v[112:115], v[100:103]
    v_mfma_f32_16x16x32_bf16 v[96:99], v[44:47], v[116:119], v[96:99]
    v_mfma_f32_16x16x32_bf16 v[100:103], v[60:63], v[116:119], v[100:103]
    s_nop 6
    v_cvt_pk_bf16_f32 v10, v96, v97
    v_cvt_pk_bf16_f32 v11, v98, v99
    v_cvt_pk_bf16_f32 v12, v100, v101
    v_cvt_pk_bf16_f32 v13, v102, v103
    v_lshlrev_b32 v96, 16, v10
    v_and_b32 v97, s65, v10
    v_lshlrev_b32 v98, 16, v11
    v_and_b32 v99, s65, v11
    v_lshlrev_b32 v100, 16, v12
    v_and_b32 v101, s65, v12
    v_lshlrev_b32 v102, 16, v13
    v_and_b32 v103, s65, v13
    v_pk_mul_f32 v[96:97], v[96:97], v[200:201] op_sel_hi:[1,0]
    v_pk_mul_f32 v[98:99], v[98:99], v[200:201] op_sel_hi:[1,0]
    v_pk_mul_f32 v[100:101], v[100:101], v[200:201] op_sel_hi:[1,0]
    v_pk_mul_f32 v[102:103], v[102:103], v[200:201] op_sel_hi:[1,0]
    v_cvt_pk_bf16_f32 v10, v96, v97
    v_cvt_pk_bf16_f32 v11, v98, v99
    v_cvt_pk_bf16_f32 v12, v100, v101
    v_cvt_pk_bf16_f32 v13, v102, v103
    v_lshlrev_b32 v96, 16, v10
    v_and_b32 v97, s65, v10
    v_lshlrev_b32 v98, 16, v11
    v_and_b32 v99, s65, v11
    v_lshlrev_b32 v100, 16, v12
    v_and_b32 v101, s65, v12
    v_lshlrev_b32 v102, 16, v13
    v_and_b32 v103, s65, v13
    v_max3_f32 v14, v96, v97, v98
    v_max3_f32 v15, v99, v100, v101
    v_max3_f32 v14, v14, v102, v103
    v_max_f32 v14, v14, v15
    v_mov_b32 v15, v14
    s_nop 1
    v_permlane16_swap_b32 v14, v15
    v_max_f32 v14, v14, v15
    v_mov_b32 v15, v14
    s_nop 1
    v_permlane32_swap_b32 v14, v15
    v_max_f32 v14, v14, v15
    v_mul_f32 v204, s66, v14
    v_pk_fma_f32 v[96:97], v[96:97], v[202:203], v[204:205] op_sel_hi:[1,0,0] neg_lo:[0,0,1] neg_hi:[0,0,1]
    v_pk_fma_f32 v[98:99], v[98:99], v[202:203], v[204:205] op_sel_hi:[1,0,0] neg_lo:[0,0,1] neg_hi:[0,0,1]
    v_exp_f32 v96, v96
    v_exp_f32 v97, v97
    v_exp_f32 v98, v98
    v_exp_f32 v99, v99
    v_pk_fma_f32 v[100:101], v[100:101], v[202:203], v[204:205] op_sel_hi:[1,0,0] neg_lo:[0,0,1] neg_hi:[0,0,1]
    v_pk_add_f32 v[16:17], v[96:97], v[98:99]
    v_cvt_pk_bf16_f32 v96, v96, v96
    v_and_b32 v210, v96, v8
    v_and_b32 v211, v96, v9
    v_cvt_pk_bf16_f32 v97, v97, v97
    v_and_b32 v214, v97, v8
    v_mfma_f32_16x16x32_bf16 v[104:107], v[210:213], v[128:131], 0
    v_mfma_f32_16x16x32_bf16 v[108:111], v[208:211], v[128:131], 0
    v_and_b32 v215, v97, v9
    v_cvt_pk_bf16_f32 v98, v98, v98
    v_and_b32 v218, v98, v8
    v_mfma_f32_16x16x32_bf16 v[104:107], v[214:217], v[132:135], v[104:107]
    v_mfma_f32_16x16x32_bf16 v[108:111], v[212:215], v[132:135], v[108:111]
    v_and_b32 v219, v98, v9
    v_pk_fma_f32 v[102:103], v[102:103], v[202:203], v[204:205] op_sel_hi:[1,0,0] neg_lo:[0,0,1] neg_hi:[0,0,1]
    v_cvt_pk_bf16_f32 v99, v99, v99
    v_mfma_f32_16x16x32_bf16 v[104:107], v[218:221], v[136:139], v[104:107]
    v_mfma_f32_16x16x32_bf16 v[108:111], v[216:219], v[136:139], v[108:111]
    v_exp_f32 v100, v100
    v_exp_f32 v101, v101
    v_exp_f32 v102, v102
    v_exp_f32 v103, v103
    v_and_b32 v222, v99, v8
    v_and_b32 v223, v99, v9
    v_pk_add_f32 v[18:19], v[100:101], v[102:103]
    v_cvt_pk_bf16_f32 v100, v100, v100
    v_mfma_f32_16x16x32_bf16 v[104:107], v[222:225], v[140:143], v[104:107]
    v_mfma_f32_16x16x32_bf16 v[108:111], v[220:223], v[140:143], v[108:111]
    v_and_b32 v226, v100, v8
    v_and_b32 v227, v100, v9
    v_pk_add_f32 v[16:17], v[16:17], v[18:19]
    v_add_f32 v15, v16, v17
    v_cvt_pk_bf16_f32 v101, v101, v101
    v_mfma_f32_16x16x32_bf16 v[104:107], v[226:229], v[144:147], v[104:107]
    v_mfma_f32_16x16x32_bf16 v[108:111], v[224:227], v[144:147], v[108:111]
    v_and_b32 v230, v101, v8
    v_and_b32 v231, v101, v9
    v_mov_b32 v16, v15
    v_cvt_pk_bf16_f32 v102, v102, v102
    v_mfma_f32_16x16x32_bf16 v[104:107], v[230:233], v[148:151], v[104:107]
    v_permlane16_swap_b32 v15, v16
    v_mfma_f32_16x16x32_bf16 v[108:111], v[228:231], v[148:151], v[108:111]
    v_and_b32 v234, v102, v8
    v_and_b32 v235, v102, v9
    v_add_f32 v15, v15, v16
    v_mov_b32 v16, v15
    v_cvt_pk_bf16_f32 v103, v103, v103
    v_mfma_f32_16x16x32_bf16 v[104:107], v[234:237], v[152:155], v[104:107]
    v_mfma_f32_16x16x32_bf16 v[108:111], v[232:235], v[152:155], v[108:111]
    v_and_b32 v238, v103, v8
    v_and_b32 v239, v103, v9
    v_permlane32_swap_b32 v15, v16
    v_add_f32 v15, v15, v16
    v_mfma_f32_16x16x32_bf16 v[104:107], v[238:241], v[156:159], v[104:107]
    v_mfma_f32_16x16x32_bf16 v[108:111], v[236:239], v[156:159], v[108:111]
    s_branch L_tj_54
L_t1_52:
    s_nop 5
    v_mfma_f32_16x16x32_bf16 v[96:99], v[32:35], v[104:107], 0
    v_mfma_f32_16x16x32_bf16 v[96:99], v[36:39], v[108:111], v[96:99]
    v_mfma_f32_16x16x32_bf16 v[96:99], v[40:43], v[112:115], v[96:99]
    v_mfma_f32_16x16x32_bf16 v[96:99], v[44:47], v[116:119], v[96:99]
    s_nop 7
    v_cvt_pk_bf16_f32 v10, v96, v97
    v_cvt_pk_bf16_f32 v11, v98, v99
    v_lshlrev_b32 v96, 16, v10
    v_and_b32 v97, s65, v10
    v_lshlrev_b32 v98, 16, v11
    v_and_b32 v99, s65, v11
    v_pk_mul_f32 v[96:97], v[96:97], v[200:201] op_sel_hi:[1,0]
    v_pk_mul_f32 v[98:99], v[98:99], v[200:201] op_sel_hi:[1,0]
    v_cvt_pk_bf16_f32 v10, v96, v97
    v_cvt_pk_bf16_f32 v11, v98, v99
    v_lshlrev_b32 v96, 16, v10
    v_and_b32 v97, s65, v10
    v_lshlrev_b32 v98, 16, v11
    v_and_b32 v99, s65, v11
    v_max3_f32 v14, v96, v97, v98
    v_max_f32 v14, v14, v99
    v_mov_b32 v15, v14
    s_nop 1
    v_permlane16_swap_b32 v14, v15
    v_max_f32 v14, v14, v15
    v_mov_b32 v15, v14
    s_nop 1
    v_permlane32_swap_b32 v14, v15
    v_max_f32 v14, v14, v15
    v_mul_f32 v204, s66, v14
    v_pk_fma_f32 v[96:97], v[96:97], v[202:203], v[204:205] op_sel_hi:[1,0,0] neg_lo:[0,0,1] neg_hi:[0,0,1]
    v_pk_fma_f32 v[98:99], v[98:99], v[202:203], v[204:205] op_sel_hi:[1,0,0] neg_lo:[0,0,1] neg_hi:[0,0,1]
    v_exp_f32 v96, v96
    v_exp_f32 v97, v97
    v_exp_f32 v98, v98
    v_exp_f32 v99, v99
    s_nop 0
    v_pk_add_f32 v[16:17], v[96:97], v[98:99]
    v_cvt_pk_bf16_f32 v96, v96, v96
    v_and_b32 v210, v96, v8
    v_and_b32 v211, v96, v9
    v_add_f32 v15, v16, v17
    v_cvt_pk_bf16_f32 v97, v97, v97
    v_mfma_f32_16x16x32_bf16 v[104:107], v[210:213], v[128:131], 0
    v_mfma_f32_16x16x32_bf16 v[108:111], v[208:211], v[128:131], 0
    v_and_b32 v214, v97, v8
    v_and_b32 v215, v97, v9
    v_mov_b32 v16, v15
    v_cvt_pk_bf16_f32 v98, v98, v98
    v_mfma_f32_16x16x32_bf16 v[104:107], v[214:217], v[132:135], v[104:107]
    v_permlane16_swap_b32 v15, v16
    v_mfma_f32_16x16x32_bf16 v[108:111], v[212:215], v[132:135], v[108:111]
    v_and_b32 v218, v98, v8
    v_and_b32 v219, v98, v9
    v_add_f32 v15, v15, v16
    v_mov_b32 v16, v15
    v_cvt_pk_bf16_f32 v99, v99, v99
    v_mfma_f32_16x16x32_bf16 v[104:107], v[218:221], v[136:139], v[104:107]
    v_mfma_f32_16x16x32_bf16 v[108:111], v[216:219], v[136:139], v[108:111]
    v_and_b32 v222, v99, v8
    v_and_b32 v223, v99, v9
    v_permlane32_swap_b32 v15, v16
    v_add_f32 v15, v15, v16
    v_mfma_f32_16x16x32_bf16 v[104:107], v[222:225], v[140:143], v[104:107]
    v_mfma_f32_16x16x32_bf16 v[108:111], v[220:223], v[140:143], v[108:111]
L_tj_54:
    ds_write_b32 v199, v14
    ds_write_b32 v199, v15 offset:128
    s_nop 4
    ds_write_b128 v206, v[104:107]
    ds_write_b128 v206, v[108:111] offset:16
    s_waitcnt lgkmcnt(0)
    s_barrier
    ds_read_b32 v31, v250
    ds_read_b128 v[16:19], v207
    ds_read_b128 v[20:23], v207 offset:16
    ds_read2_b32 v[24:25], v243 offset0:0 offset1:4
    ds_read2_b32 v[26:27], v243 offset0:32 offset1:36
    ds_read_b128 v[32:35], v242
    ds_read_b128 v[36:39], v242 offset:8448
    s_waitcnt lgkmcnt(2)
    v_max3_f32 v112, v16, v17, v18
    v_max3_f32 v113, v19, v20, v21
    v_max3_f32 v112, v112, v22, v23
    v_max_f32 v112, v112, v113
    v_sub_f32 v24, v24, v112
    v_sub_f32 v25, v25, v112
    v_mul_f32 v24, s66, v24
    v_mul_f32 v25, s66, v25
    v_exp_f32 v24, v24
    v_exp_f32 v25, v25
    v_mul_f32 v113, v24, v26
    v_fmac_f32 v113, v25, v27
    v_mov_b32 v114, 0
    v_readfirstlane_b32 s14, v31
    v_add_f32_dpp v113, v113, v113 quad_perm:[1,0,3,2] row_mask:0xf bank_mask:0xf
    v_and_or_b32 v44, v112, v3, s61
    v_and_or_b32 v46, v114, v3, s63
    v_add_f32_dpp v113, v113, v113 quad_perm:[2,3,0,1] row_mask:0xf bank_mask:0xf
    v_and_or_b32 v45, v113, v3, s62
    v_and_or_b32 v47, v114, v3, s64
    s_waitcnt lgkmcnt(0)
    v_mul_f32 v116, v24, v32
    v_mul_f32 v117, v24, v33
    v_mul_f32 v118, v24, v34
    v_mul_f32 v119, v24, v35
    v_fmac_f32 v116, v25, v36
    v_fmac_f32 v117, v25, v37
    v_fmac_f32 v118, v25, v38
    v_fmac_f32 v119, v25, v39
    v_add_f32_dpp v116, v116, v116 quad_perm:[1,0,3,2] row_mask:0xf bank_mask:0xf
    v_add_f32_dpp v117, v117, v117 quad_perm:[1,0,3,2] row_mask:0xf bank_mask:0xf
    v_add_f32_dpp v118, v118, v118 quad_perm:[1,0,3,2] row_mask:0xf bank_mask:0xf
    v_add_f32_dpp v119, v119, v119 quad_perm:[1,0,3,2] row_mask:0xf bank_mask:0xf
    v_add_f32_dpp v116, v116, v116 quad_perm:[2,3,0,1] row_mask:0xf bank_mask:0xf
    v_add_f32_dpp v117, v117, v117 quad_perm:[2,3,0,1] row_mask:0xf bank_mask:0xf
    v_add_f32_dpp v118, v118, v118 quad_perm:[2,3,0,1] row_mask:0xf bank_mask:0xf
    v_add_f32_dpp v119, v119, v119 quad_perm:[2,3,0,1] row_mask:0xf bank_mask:0xf
    v_and_or_b32 v40, v116, v3, s61
    v_and_or_b32 v41, v117, v3, s62
    v_and_or_b32 v42, v118, v3, s63
    v_and_or_b32 v43, v119, v3, s64
    s_cmp_eq_u32 s14, 0
    s_cbranch_scc1 L_aslow_55
    s_mov_b64 exec, s[100:101]
    buffer_store_dwordx4 v[40:43], v248, s[44:47], 0 offen
    s_mov_b64 exec, 1
    buffer_store_dwordx4 v[44:47], v249, s[44:47], 0 offen
    s_mov_b64 exec, -1
    s_branch L_adone_56
L_aslow_55:
    s_mov_b64 exec, s[100:101]
    buffer_store_dwordx4 v[40:43], v248, s[44:47], 0 offen sc1
    s_mov_b64 exec, 1
    buffer_store_dwordx4 v[44:47], v249, s[44:47], 0 offen sc1
    s_mov_b64 exec, -1
L_adone_56:
    s_cmp_eq_u32 s3, 7
    s_cbranch_scc1 L_Z
L_F:
    s_barrier
    s_mov_b32 s48, s28
    s_mov_b32 s49, s29
    s_mov_b32 s50, 0x1c0000
    s_mov_b32 s51, 0x20000
    buffer_load_dwordx4 v[120:123], v183, s[48:51], 0 offen nt
    s_mov_b32 s72, 0x3800
    s_mov_b32 s52, s30
    s_mov_b32 s53, s31
    s_mov_b32 s54, 0x1c0000
    s_mov_b32 s55, 0x20000
    buffer_load_dwordx4 v[124:127], v183, s[48:51], s72 offen nt
    buffer_load_dwordx4 v[128:131], v183, s[52:55], 0 offen nt
    s_mov_b32 s72, 0x3800
    s_mov_b32 s56, s32
    s_mov_b32 s57, s33
    s_mov_b32 s58, 0x1c0000
    s_mov_b32 s59, 0x20000
    buffer_load_dwordx4 v[132:135], v183, s[52:55], s72 offen nt
    s_cmp_ge_u32 s5, 4
    s_cbranch_scc1 L_nodown_59
    buffer_load_dwordx4 v[136:139], v184, s[56:59], 0 offen nt
    s_mov_b32 s72, 0x1000
    buffer_load_dwordx4 v[140:143], v184, s[56:59], s72 offen nt
    s_mov_b32 s72, 0x2000
    buffer_load_dwordx4 v[144:147], v184, s[56:59], s72 offen nt
    s_mov_b32 s72, 0x3000
    buffer_load_dwordx4 v[148:151], v184, s[56:59], s72 offen nt
L_nodown_59:
    s_mov_b32 s76, s16
    s_mov_b32 s77, s17
    s_mov_b32 s78, 0x400
    s_mov_b32 s79, 0x20000
    buffer_load_ushort v21, v171, s[76:79], 0 offen
    v_mov_b32 v186, 21136
    s_mov_b32 s99, 0x3b000000
    s_mov_b32 s98, 0x3727c5ac
    s_mov_b32 s68, 0
L_m2_60:
    buffer_load_dwordx4 v[64:67], v172, s[44:47], 0 offen sc1
    buffer_load_dwordx4 v[68:71], v173, s[44:47], 0 offen sc1
    s_waitcnt vmcnt(0)
    v_xor_b32 v64, s61, v64
    v_xor_b32 v68, s61, v68
    v_or_b32 v24, v64, v68
    v_and_b32 v25, 0xff, v24
    v_cmp_ne_u32 vcc, 0, v25
    s_nop 0
    s_cbranch_vccnz L_m2_r_61
    v_xor_b32 v65, s62, v65
    v_xor_b32 v66, s63, v66
    v_xor_b32 v67, s64, v67
    v_xor_b32 v69, s62, v69
    v_xor_b32 v70, s63, v70
    v_or3_b32 v24, v65, v66, v67
    v_xor_b32 v71, s64, v71
    v_or3_b32 v24, v69, v70, v24
    v_or_b32 v24, v24, v71
    v_and_b32 v24, 0xff, v24
    v_cmp_ne_u32 vcc, 0, v24
    s_nop 0
    s_cbranch_vccz L_m2_ok_62
L_m2_r_61:
    s_add_u32 s68, s68, 1
    s_cmp_lt_u32 s68, 32768
    s_cbranch_scc1 L_m2_60
    s_branch L_end
L_m2_ok_62:
    v_permlane32_swap_b32 v68, v70
    v_permlane32_swap_b32 v69, v71
    v_add_f32 v68, v68, v70
    v_add_f32 v69, v69, v71
    v_permlane32_swap_b32 v64, v66
    v_permlane32_swap_b32 v65, v67
    v_permlane16_swap_b32 v68, v69
    v_add_f32 v68, v68, v69
    v_add_f32 v64, v64, v66
    v_add_f32 v65, v65, v67
    v_cvt_pk_bf16_f32 v68, v68, v68
    v_and_b32 v68, s65, v68
    v_permlane16_swap_b32 v64, v65
    v_add_f32 v64, v64, v65
    v_mov_b32_dpp v69, v68 quad_perm:[2,3,0,1] row_mask:0xf bank_mask:0xf
    v_add_f32 v69, 1.0, v69
    v_cvt_pk_bf16_f32 v64, v64, v64
    v_cvt_pk_bf16_f32 v69, v69, v69
    v_and_b32 v64, s65, v64
    v_and_b32 v69, s65, v69
    v_lshlrev_b32 v21, 16, v21
    s_mov_b32 s73, 0x2000
    s_mov_b32 s74, 0x4000
    s_mov_b32 s75, 0x6000
    s_mov_b32 s68, 0
L_e4_l_63:
    buffer_load_dwordx4 v[72:75], v185, s[44:47], 0 offen sc1
    s_waitcnt vmcnt(0)
    v_xor_b32 v72, s61, v72
    v_xor_b32 v73, s62, v73
    v_xor_b32 v74, s63, v74
    v_xor_b32 v75, s64, v75
    v_or3_b32 v24, v72, v73, v74
    v_or_b32 v24, v24, v75
    v_and_b32 v24, 0xff, v24
    v_cmp_ne_u32 s[70:71], 0, v24
    s_nop 0
    s_cmp_eq_u64 s[70:71], 0
    s_cbranch_scc1 L_e4_lok_64
    s_add_u32 s68, s68, 1
    s_cmp_lt_u32 s68, 32768
    s_cbranch_scc1 L_e4_l_63
    s_branch L_end
L_e4_lok_64:
    s_mov_b32 s68, 0
L_e4_65:
    buffer_load_dwordx4 v[72:75], v174, s[44:47], 0 offen sc1
    buffer_load_dwordx4 v[76:79], v174, s[44:47], s73 offen sc1
    buffer_load_dwordx4 v[80:83], v174, s[44:47], s74 offen sc1
    buffer_load_dwordx4 v[84:87], v174, s[44:47], s75 offen sc1
    s_waitcnt vmcnt(0)
    v_xor_b32 v72, s61, v72
    v_xor_b32 v76, s61, v76
    v_xor_b32 v80, s61, v80
    v_xor_b32 v84, s61, v84
    v_or3_b32 v24, v72, v76, v80
    v_or_b32 v24, v24, v84
    v_and_b32 v25, 0xff, v24
    v_cmp_ne_u32 vcc, 0, v25
    s_nop 0
    s_cbranch_vccnz L_e4_r_66
    v_xor_b32 v73, s62, v73
    v_xor_b32 v74, s63, v74
    v_xor_b32 v75, s64, v75
    v_xor_b32 v77, s62, v77
    v_xor_b32 v78, s63, v78
    v_or3_b32 v24, v73, v74, v75
    v_xor_b32 v79, s64, v79
    v_or3_b32 v24, v77, v78, v24
    v_xor_b32 v81, s62, v81
    v_xor_b32 v82, s63, v82
    v_or_b32 v24, v24, v79
    v_xor_b32 v83, s64, v83
    v_or3_b32 v24, v81, v82, v24
    v_xor_b32 v85, s62, v85
    v_xor_b32 v86, s63, v86
    v_or_b32 v24, v24, v83
    v_xor_b32 v87, s64, v87
    v_or3_b32 v24, v85, v86, v24
    v_or_b32 v24, v24, v87
    v_and_b32 v24, 0xff, v24
    v_cmp_ne_u32 vcc, 0, v24
    s_nop 0
    s_cbranch_vccz L_e4_ok_67
L_e4_r_66:
    s_add_u32 s68, s68, 1
    s_cmp_lt_u32 s68, 32768
    s_cbranch_scc1 L_e4_65
    s_branch L_end
L_e4_ok_67:
    v_add_f32 v72, v72, v76
    v_add_f32 v80, v80, v84
    v_add_f32 v73, v73, v77
    v_add_f32 v81, v81, v85
    v_add_f32 v74, v74, v78
    v_add_f32 v82, v82, v86
    v_add_f32 v75, v75, v79
    v_add_f32 v83, v83, v87
    v_add_f32 v72, v72, v80
    v_add_f32 v73, v73, v81
    v_add_f32 v74, v74, v82
    v_add_f32 v75, v75, v83
    s_nop 0
    v_permlane32_swap_b32 v72, v74
    v_permlane32_swap_b32 v73, v75
    v_add_f32 v72, v72, v74
    v_add_f32 v73, v73, v75
    s_nop 1
    v_permlane16_swap_b32 v72, v73
    v_add_f32 v72, v72, v73
    v_cvt_pk_bf16_f32 v72, v72, v72
    v_and_b32 v72, s65, v72
    v_mul_f32 v72, v64, v72
    v_cvt_pk_bf16_f32 v72, v72, v72
    v_and_b32 v72, s65, v72
    v_add_f32 v72, v21, v72
    v_cvt_pk_bf16_f32 v72, v72, v72
    v_and_b32 v72, s65, v72
    v_mul_f32 v73, v72, v72
    ds_write_b32 v175, v72 offset:18176
    v_add_f32_dpp v72, v72, v72 row_ror:8 row_mask:0xf bank_mask:0xf
    v_add_f32_dpp v73, v73, v73 row_ror:8 row_mask:0xf bank_mask:0xf
    s_nop 0
    v_add_f32_dpp v72, v72, v72 row_ror:4 row_mask:0xf bank_mask:0xf
    v_add_f32_dpp v73, v73, v73 row_ror:4 row_mask:0xf bank_mask:0xf
    s_nop 0
    v_add_f32_dpp v72, v72, v72 row_ror:2 row_mask:0xf bank_mask:0xf
    v_add_f32_dpp v73, v73, v73 row_ror:2 row_mask:0xf bank_mask:0xf
    s_nop 0
    v_add_f32_dpp v72, v72, v72 row_ror:1 row_mask:0xf bank_mask:0xf
    v_add_f32_dpp v73, v73, v73 row_ror:1 row_mask:0xf bank_mask:0xf
    v_mov_b32 v74, v72
    v_mov_b32 v75, v73
    s_nop 0
    v_permlane16_swap_b32 v72, v74
    v_permlane16_swap_b32 v73, v75
    v_add_f32 v72, v72, v74
    v_add_f32 v73, v73, v75
    v_mov_b32 v74, v72
    v_mov_b32 v75, v73
    s_nop 0
    v_permlane32_swap_b32 v72, v74
    v_permlane32_swap_b32 v73, v75
    v_add_f32 v72, v72, v74
    v_add_f32 v73, v73, v75
    s_mov_b64 exec, 1
    ds_write_b64 v176, v[72:73]
    s_mov_b64 exec, -1
    s_waitcnt lgkmcnt(0)
    s_barrier
    ds_read_b128 v[72:75], v186 offset:0
    ds_read_b128 v[76:79], v186 offset:16
    ds_read_b128 v[80:83], v186 offset:32
    ds_read_b128 v[84:87], v186 offset:48
    ds_read_b32 v21, v177 offset:18176
    s_waitcnt lgkmcnt(0)
    v_pk_add_f32 v[72:73], v[72:73], v[74:75]
    v_pk_add_f32 v[76:77], v[76:77], v[78:79]
    v_pk_add_f32 v[80:81], v[80:81], v[82:83]
    v_pk_add_f32 v[84:85], v[84:85], v[86:87]
    v_pk_add_f32 v[72:73], v[72:73], v[76:77]
    v_pk_add_f32 v[80:81], v[80:81], v[84:85]
    v_pk_add_f32 v[72:73], v[72:73], v[80:81]
    v_mul_f32 v72, s99, v72
    v_mul_f32 v73, s99, v73
    v_fma_f32 v73, -v72, v72, v73
    v_max_f32 v73, 0, v73
    v_cvt_pk_bf16_f32 v73, v73, v73
    v_and_b32 v73, s65, v73
    v_add_f32 v73, s98, v73
    v_cvt_pk_bf16_f32 v73, v73, v73
    v_and_b32 v73, s65, v73
    v_sqrt_f32 v73, v73
    v_cvt_pk_bf16_f32 v22, v72, v72
    v_and_b32 v22, s65, v22
    v_cvt_pk_bf16_f32 v23, v73, v73
    v_and_b32 v23, s65, v23
    v_sub_f32 v24, v21, v22
    v_cvt_pk_bf16_f32 v24, v24, v24
    v_rcp_f32 v25, v23
    v_and_b32 v24, s65, v24
    v_mul_f32 v21, v24, v25
    v_fma_f32 v26, -v21, v23, v24
    v_fma_f32 v21, v26, v25, v21
    v_cvt_pk_bf16_f32 v21, v21, v21
    v_and_b32 v21, s65, v21
    v_mul_f32 v24, v21, v69
    v_cvt_pk_bf16_f32 v24, v24, v24
    v_and_b32 v24, s65, v24
    v_add_f32 v24, v24, v68
    v_cvt_pk_bf16_f32 v20, v24, v24
    s_nop 1
    v_mov_b32_dpp v163, v20 row_newbcast:0 row_mask:0xf bank_mask:0xf
    v_and_b32 v160, v163, v4
    v_and_b32 v161, v163, v5
    v_and_b32 v162, v163, v6
    v_and_b32 v163, v163, v7
    v_mov_b32_dpp v167, v20 row_newbcast:1 row_mask:0xf bank_mask:0xf
    v_and_b32 v164, v167, v4
    v_mfma_f32_16x16x32_bf16 v[88:91], v[160:163], v[120:123], 0
    v_mfma_f32_16x16x32_bf16 v[92:95], v[160:163], v[128:131], 0
    v_and_b32 v165, v167, v5
    v_and_b32 v166, v167, v6
    v_and_b32 v167, v167, v7
    s_nop 1
    v_mfma_f32_16x16x32_bf16 v[88:91], v[164:167], v[124:127], v[88:91]
    v_mfma_f32_16x16x32_bf16 v[92:95], v[164:167], v[132:135], v[92:95]
    s_mov_b32 exec_hi, 0
    s_nop 5
    ds_write_b128 v178, v[88:91]
    ds_write_b128 v178, v[92:95] offset:4608
    s_mov_b64 exec, -1
    s_waitcnt lgkmcnt(0)
    s_barrier
    s_cmp_ge_u32 s5, 4
    s_cbranch_scc1 L_fin
    ds_read_b128 v[32:35], v179 offset:0
    ds_read_b128 v[36:39], v179 offset:2304
    s_waitcnt lgkmcnt(0)
    v_add_f32 v32, v32, v36
    v_add_f32 v33, v33, v37
    v_add_f32 v34, v34, v38
    v_add_f32 v35, v35, v39
    v_add_f32_dpp v32, v32, v32 quad_perm:[1,0,3,2] row_mask:0xf bank_mask:0xf
    v_add_f32_dpp v33, v33, v33 quad_perm:[1,0,3,2] row_mask:0xf bank_mask:0xf
    v_add_f32_dpp v34, v34, v34 quad_perm:[1,0,3,2] row_mask:0xf bank_mask:0xf
    v_add_f32_dpp v35, v35, v35 quad_perm:[1,0,3,2] row_mask:0xf bank_mask:0xf
    v_add_f32_dpp v32, v32, v32 quad_perm:[2,3,0,1] row_mask:0xf bank_mask:0xf
    v_add_f32_dpp v33, v33, v33 quad_perm:[2,3,0,1] row_mask:0xf bank_mask:0xf
    v_add_f32_dpp v34, v34, v34 quad_perm:[2,3,0,1] row_mask:0xf bank_mask:0xf
    v_add_f32_dpp v35, v35, v35 quad_perm:[2,3,0,1] row_mask:0xf bank_mask:0xf
    v_and_or_b32 v16, v32, v3, s61
    v_and_or_b32 v17, v33, v3, s62
    v_and_or_b32 v18, v34, v3, s63
    v_and_or_b32 v19, v35, v3, s64
    s_mov_b64 exec, s[100:101]
    s_cmp_eq_u32 s14, 0
    s_cbranch_scc1 L_slow_68
    buffer_store_dwordx4 v[16:19], v180, s[44:47], 0 offen
    s_branch L_std_69
L_slow_68:
    buffer_store_dwordx4 v[16:19], v180, s[44:47], 0 offen sc1
L_std_69:
    s_mov_b64 exec, -1
    s_mov_b32 s68, 0
L_e4b_70:
    buffer_load_dwordx4 v[64:67], v181, s[44:47], 0 offen sc1
    s_waitcnt vmcnt(0)
    v_xor_b32 v64, s61, v64
    v_xor_b32 v65, s62, v65
    v_xor_b32 v66, s63, v66
    v_xor_b32 v67, s64, v67
    v_or3_b32 v24, v64, v65, v66
    v_or_b32 v24, v24, v67
    v_and_b32 v24, 0xff, v24
    v_cmp_ne_u32 s[70:71], 0, v24
    s_nop 0
    s_cmp_eq_u64 s[70:71], 0
    s_cbranch_scc1 L_e4b_ok_72
L_e4b_r_71:
    s_add_u32 s68, s68, 1
    s_cmp_lt_u32 s68, 32768
    s_cbranch_scc1 L_e4b_70
    s_branch L_end
L_e4b_ok_72:
    v_permlane32_swap_b32 v64, v66
    v_permlane32_swap_b32 v65, v67
    v_add_f32 v64, v64, v66
    v_add_f32 v65, v65, v67
    s_nop 1
    v_permlane16_swap_b32 v64, v65
    v_add_f32 v64, v64, v65
    s_nop 1
    v_add_f32_dpp v64, v64, v64 row_ror:8 row_mask:0xf bank_mask:0xf
    v_cvt_pk_bf16_f32 v64, v64, v64
    v_and_b32 v64, s65, v64
    s_nop 1
    v_mov_b32_dpp v65, v64 row_ror:4 row_mask:0xf bank_mask:0xf
    v_mul_f32 v64, v64, v65
    v_cvt_pk_bf16_f32 v20, v64, v64
    s_nop 1
    v_mov_b32_dpp v163, v20 row_newbcast:0 row_mask:0xf bank_mask:0xf
    v_and_b32 v160, v163, v4
    v_and_b32 v161, v163, v5
    v_and_b32 v162, v163, v6
    v_and_b32 v163, v163, v7
    v_mov_b32_dpp v167, v20 row_newbcast:1 row_mask:0xf bank_mask:0xf
    v_and_b32 v164, v167, v4
    v_mfma_f32_16x16x32_bf16 v[88:91], v[160:163], v[136:139], 0
    v_and_b32 v165, v167, v5
    v_and_b32 v166, v167, v6
    v_and_b32 v167, v167, v7
    v_mov_b32_dpp v171, v20 row_newbcast:2 row_mask:0xf bank_mask:0xf
    v_and_b32 v168, v171, v4
    v_mfma_f32_16x16x32_bf16 v[88:91], v[164:167], v[140:143], v[88:91]
    v_and_b32 v169, v171, v5
    v_and_b32 v170, v171, v6
    v_and_b32 v171, v171, v7
    v_mov_b32_dpp v175, v20 row_newbcast:3 row_mask:0xf bank_mask:0xf
    v_and_b32 v172, v175, v4
    v_mfma_f32_16x16x32_bf16 v[88:91], v[168:171], v[144:147], v[88:91]
    v_and_b32 v173, v175, v5
    v_and_b32 v174, v175, v6
    v_and_b32 v175, v175, v7
    s_nop 1
    v_mfma_f32_16x16x32_bf16 v[88:91], v[172:175], v[148:151], v[88:91]
    s_nop 7
    v_and_or_b32 v16, v88, v3, s61
    v_and_or_b32 v17, v89, v3, s62
    v_and_or_b32 v18, v90, v3, s63
    v_and_or_b32 v19, v91, v3, s64
    s_mov_b32 exec_hi, 0
    buffer_store_dwordx4 v[16:19], v182, s[44:47], 0 offen sc1
    s_mov_b64 exec, -1
    s_branch L_fin
L_Z:
    s_cmp_eq_u32 s5, 7
    s_cbranch_scc1 L_Z7
    s_mov_b32 s73, 0x4000
    s_mov_b32 s68, 0
L_e5_l_73:
    buffer_load_dwordx4 v[36:39], v174, s[44:47], 0 offen sc1
    s_waitcnt vmcnt(0)
    v_xor_b32 v36, s61, v36
    v_xor_b32 v37, s62, v37
    v_xor_b32 v38, s63, v38
    v_xor_b32 v39, s64, v39
    v_or3_b32 v24, v36, v37, v38
    v_or_b32 v24, v24, v39
    v_and_b32 v24, 0xff, v24
    v_cmp_ne_u32 s[70:71], 0, v24
    s_nop 0
    s_cmp_eq_u64 s[70:71], 0
    s_cbranch_scc1 L_e5_lok_74
    s_add_u32 s68, s68, 1
    s_cmp_lt_u32 s68, 32768
    s_cbranch_scc1 L_e5_l_73
    s_branch L_end
L_e5_lok_74:
    s_mov_b32 s68, 0
L_e5_75:
    buffer_load_dwordx4 v[32:35], v172, s[44:47], 0 offen sc1
    buffer_load_dwordx4 v[36:39], v172, s[44:47], s73 offen sc1
    s_waitcnt vmcnt(0)
    v_xor_b32 v32, s61, v32
    v_xor_b32 v36, s61, v36
    v_or_b32 v24, v32, v36
    v_and_b32 v25, 0xff, v24
    v_cmp_ne_u32 vcc, 0, v25
    s_nop 0
    s_cbranch_vccnz L_e5_r_76
    v_xor_b32 v33, s62, v33
    v_xor_b32 v34, s63, v34
    v_xor_b32 v35, s64, v35
    v_xor_b32 v37, s62, v37
    v_xor_b32 v38, s63, v38
    v_or3_b32 v24, v33, v34, v35
    v_xor_b32 v39, s64, v39
    v_or3_b32 v24, v37, v38, v24
    v_or_b32 v24, v24, v39
    v_and_b32 v24, 0xff, v24
    v_cmp_ne_u32 vcc, 0, v24
    s_nop 0
    s_cbranch_vccz L_e5_ok_77
L_e5_r_76:
    s_add_u32 s68, s68, 1
    s_cmp_lt_u32 s68, 32768
    s_cbranch_scc1 L_e5_75
    s_branch L_end
L_e5_ok_77:
    v_add_f32 v32, v32, v36
    v_add_f32 v33, v33, v37
    v_add_f32 v34, v34, v38
    v_add_f32 v35, v35, v39
    s_nop 0
    v_permlane32_swap_b32 v32, v34
    v_permlane32_swap_b32 v33, v35
    v_add_f32 v32, v32, v34
    v_add_f32 v33, v33, v35
    s_nop 1
    v_permlane16_swap_b32 v32, v33
    v_add_f32 v32, v32, v33
    s_nop 1
    v_add_f32_dpp v32, v32, v32 row_ror:8 row_mask:0xf bank_mask:0xf
    ds_write_b32 v176, v32 offset:20224
    s_waitcnt lgkmcnt(0)
    s_barrier
    s_branch L_fin
L_Z7:
    s_mov_b32 s76, s16
    s_mov_b32 s77, s17
    s_mov_b32 s78, 0x400
    s_mov_b32 s79, 0x20000
    s_mov_b32 s48, s38
    s_mov_b32 s49, s39
    s_mov_b32 s50, 0x400
    s_mov_b32 s51, 0x20000
    buffer_load_ushort v21, v171, s[76:79], 0 offen
    s_mov_b32 s68, 0
L_zm2_78:
    buffer_load_dwordx4 v[40:43], v173, s[44:47], 0 offen sc1
    s_waitcnt vmcnt(0)
    v_xor_b32 v40, s61, v40
    v_xor_b32 v41, s62, v41
    v_xor_b32 v42, s63, v42
    v_xor_b32 v43, s64, v43
    v_or3_b32 v24, v40, v41, v42
    v_or_b32 v24, v24, v43
    v_and_b32 v24, 0xff, v24
    v_cmp_ne_u32 s[70:71], 0, v24
    s_nop 0
    s_cmp_eq_u64 s[70:71], 0
    s_cbranch_scc1 L_zm2_ok_80
L_zm2_r_79:
    s_add_u32 s68, s68, 1
    s_cmp_lt_u32 s68, 32768
    s_cbranch_scc1 L_zm2_78
    s_branch L_end
L_zm2_ok_80:
    v_permlane32_swap_b32 v40, v42
    v_permlane32_swap_b32 v41, v43
    v_add_f32 v40, v40, v42
    v_add_f32 v41, v41, v43
    s_mov_b32 s73, 0x4000
    s_mov_b32 s68, 0
    v_permlane16_swap_b32 v40, v41
    v_add_f32 v40, v40, v41
    v_cvt_pk_bf16_f32 v40, v40, v40
    v_and_b32 v40, s65, v40
    s_nop 1
    v_mov_b32_dpp v41, v40 row_ror:8 row_mask:0xf bank_mask:0xf
L_ze4_81:
    buffer_load_dwordx4 v[32:35], v174, s[44:47], 0 offen sc1
    buffer_load_dwordx4 v[36:39], v174, s[44:47], s73 offen sc1
    s_waitcnt vmcnt(0)
    v_xor_b32 v32, s61, v32
    v_xor_b32 v36, s61, v36
    v_or_b32 v24, v32, v36
    v_and_b32 v25, 0xff, v24
    v_cmp_ne_u32 vcc, 0, v25
    s_nop 0
    s_cbranch_vccnz L_ze4_r_82
    v_xor_b32 v33, s62, v33
    v_xor_b32 v34, s63, v34
    v_xor_b32 v35, s64, v35
    v_xor_b32 v37, s62, v37
    v_xor_b32 v38, s63, v38
    v_or3_b32 v24, v33, v34, v35
    v_xor_b32 v39, s64, v39
    v_or3_b32 v24, v37, v38, v24
    v_or_b32 v24, v24, v39
    v_and_b32 v24, 0xff, v24
    v_cmp_ne_u32 vcc, 0, v24
    s_nop 0
    s_cbranch_vccz L_ze4_ok_83
L_ze4_r_82:
    s_add_u32 s68, s68, 1
    s_cmp_lt_u32 s68, 32768
    s_cbranch_scc1 L_ze4_81
    s_branch L_end
L_ze4_ok_83:
    v_add_f32 v32, v32, v36
    v_add_f32 v33, v33, v37
    v_add_f32 v34, v34, v38
    v_add_f32 v35, v35, v39
    v_lshlrev_b32 v21, 16, v21
    v_permlane32_swap_b32 v32, v34
    v_permlane32_swap_b32 v33, v35
    v_add_f32 v32, v32, v34
    v_add_f32 v33, v33, v35
    s_add_u32 s69, s67, 1
    v_cmp_eq_u32 vcc, 0, v177
    v_permlane16_swap_b32 v32, v33
    v_add_f32 v32, v32, v33
    v_mov_b32 v16, s69
    v_mov_b32 v17, 0
    v_add_f32_dpp v32, v32, v32 row_ror:8 row_mask:0xf bank_mask:0xf
    v_cvt_pk_bf16_f32 v32, v32, v32
    v_and_b32 v32, s65, v32
    v_mul_f32 v32, v40, v32
    v_cvt_pk_bf16_f32 v32, v32, v32
    v_and_b32 v32, s65, v32
    v_add_f32 v32, v21, v32
    v_cvt_pk_bf16_f32 v32, v32, v32
    v_and_b32 v32, s65, v32
    s_barrier
    ds_read_b32 v48, v175 offset:20224
    ds_read_b32 v49, v175 offset:20352
    ds_read_b32 v50, v175 offset:20480
    ds_read_b32 v51, v175 offset:20608
    ds_read_b32 v52, v175 offset:20736
    ds_read_b32 v53, v175 offset:20864
    ds_read_b32 v54, v175 offset:20992
    s_waitcnt lgkmcnt(0)
    v_add_f32 v48, v48, v49
    v_add_f32 v50, v50, v51
    v_add_f32 v52, v52, v53
    v_add_f32 v48, v48, v50
    v_add_f32 v52, v52, v54
    v_add_f32 v48, v48, v52
    v_cvt_pk_bf16_f32 v48, v48, v48
    v_and_b32 v48, s65, v48
    v_mul_f32 v48, v41, v48
    v_cvt_pk_bf16_f32 v48, v48, v48
    v_and_b32 v48, s65, v48
    v_add_f32 v48, v32, v48
    v_cvt_pk_bf16_f32 v48, v48, v48
    s_and_saveexec_b64 s[74:75], vcc
    buffer_store_short v48, v171, s[48:51], 0 offen
    s_mov_b64 exec, s[74:75]
    s_cmp_lg_u32 s6, 0
    s_cbranch_scc1 L_fin
    s_mov_b64 exec, 1
    buffer_store_dword v16, v17, s[44:47], 0 offen
    s_mov_b64 exec, -1
    s_branch L_fin
L_fin:
L_end:
    s_endpgm
L_code_end:

.section .rodata,"a"
.p2align 6
.amdhsa_kernel adaLN_cond__sliding_block_cached__glu_gated_bilinear__decode_kernel
  .amdhsa_next_free_vgpr 256
  .amdhsa_next_free_sgpr 102
  .amdhsa_accum_offset 256
  .amdhsa_group_segment_fixed_size 0
  .amdhsa_kernarg_size 112
  .amdhsa_user_sgpr_count 2
  .amdhsa_user_sgpr_kernarg_segment_ptr 1
  .amdhsa_system_sgpr_workgroup_id_x 1
  .amdhsa_float_denorm_mode_32 3
.end_amdhsa_kernel
```
